```python
import torch

def _softmax(x, axis=-1):
    return torch.softmax(x, dim=axis)
def _gelu(x):
    return torch.nn.functional.gelu(x, approximate="tanh")
def _silu(x):
    return torch.nn.functional.silu(x)
def _sigmoid(x):
    return torch.sigmoid(x)
def _layernorm(x, axis=-1, eps=1e-5):
    m = x.mean(dim=axis, keepdim=True)
    v = x.var(dim=axis, keepdim=True, unbiased=False)
    return (x - m) / torch.sqrt(v + eps)
def _scatter_add(tgt, idx, src, axis=0):
    return tgt.clone().index_add_(axis, idx, src)
def _segment_sum(src, seg, n):
    out = torch.zeros((n,) + src.shape[1:], dtype=src.dtype)
    return out.index_add_(0, seg, src)
def _pad(x, pw):
    flat = tuple(v for pair in reversed(pw) for v in pair)
    return torch.nn.functional.pad(x, flat)

kernel_name = 'standalone__sliding_block__prompt'

def setup_inputs():

    _w = (lambda a: (lambda t: t.to(torch.bfloat16) if t.is_floating_point() else t)(torch.as_tensor(a)))
    B, S, D = 1, 2048, 512
    return {
        "x": _w((lambda *s: torch.randn(*s, dtype=torch.bfloat16) * 0.4)(B, S, D)),
        "wqkv": _w((lambda *s: torch.randn(*s, dtype=torch.bfloat16) * 0.4)(D, 3 * D)),
        "wo": _w((lambda *s: torch.randn(*s, dtype=torch.bfloat16) * 0.05)(D, D)),
    }

def reference(x, wqkv, wo):
    B, S, D = x.shape
    H = 32; Dh = D // H; W = 256
    qkv = (lambda x, *d: x.permute(*d))((x @ wqkv).reshape(B, S, 3, H, Dh), 2, 0, 3, 1, 4)
    q, k, v = qkv[0], qkv[1], qkv[2]
    scores = torch.einsum("bhqd,bhkd->bhqk", q, k) * (Dh ** -0.5)
    idx = torch.arange(S)
    mask = (idx[:, None] - idx[None, :] >= 0) & (idx[:, None] - idx[None, :] < W)
    scores = torch.where(mask[None, None], scores, -1e9)
    p = _softmax(scores, axis=-1)
    o = torch.einsum("bhqk,bhkd->bhqd", p, v)
    return (lambda x, *d: x.permute(*d))(o, 0, 2, 1, 3).reshape(B, S, D) @ wo
```

```asm
; @launch kernel=qkv_kernel grid=(256,1,1) block=(512,1,1) lds=163840
; @launch kernel=attn_kernel grid=(256,1,1) block=(512,1,1) lds=32832
; @launch kernel=oproj_kernel grid=(256,1,1) block=(512,1,1) lds=131072
.amdgcn_target "amdgcn-amd-amdhsa--gfx950"
.text
.globl qkv_kernel
.p2align 8
.type qkv_kernel,@function
qkv_kernel:
    s_cmp_ge_u32 s2, 256
    s_cbranch_scc1 L_k1_end
    s_load_dwordx4 s[4:7], s[0:1], 0
    s_load_dwordx2 s[8:9], s[0:1], 40
    s_and_b32 s10, s2, 7
    s_lshr_b32 s11, s2, 3
    s_and_b32 s12, s10, 1
    s_lshl_b32 s12, s12, 2
    s_and_b32 s13, s11, 3
    s_add_u32 s12, s12, s13
    s_lshr_b32 s13, s10, 1
    s_lshl_b32 s13, s13, 3
    s_lshr_b32 s14, s11, 2
    s_add_u32 s13, s13, s14
    v_lshrrev_b32 v1, 6, v0
    v_and_b32 v2, 63, v0
    v_readfirstlane_b32 s39, v1
    v_and_b32 v3, 31, v2
    v_lshrrev_b32 v4, 5, v2
    s_and_b32 s14, s39, 3
    s_lshl_b32 s15, s13, 6
    s_cmp_ge_u32 s39, 4
    s_cbranch_scc1 L_k1_loader
    s_lshr_b32 s28, s14, 1
    s_and_b32 s29, s14, 1
    v_bfe_u32 v9, v2, 2, 2
    v_lshl_add_u32 v10, v4, 3, v9
    v_mul_u32_u24 v10, 384, v10
    v_lshrrev_b32 v9, 1, v9
    v_xor_b32 v9, s29, v9
    v_lshl_add_u32 v10, v9, 6, v10
    v_bfe_u32 v9, v2, 4, 1
    v_lshl_add_u32 v10, v9, 5, v10
    v_and_b32 v9, 3, v2
    v_lshl_add_u32 v20, v9, 3, v10
    v_add_u32 v20, 0x2000, v20
    v_bfe_u32 v9, v3, 1, 3
    v_lshlrev_b32 v10, 7, v3
    s_lshl_b32 s30, s28, 12
    v_add_u32 v10, s30, v10
    v_add_u32 v11, 0, v4
    v_xor_b32 v11, v11, v9
    v_lshl_add_u32 v21, v11, 4, v10
    v_add_u32 v11, 2, v4
    v_xor_b32 v11, v11, v9
    v_lshl_add_u32 v22, v11, 4, v10
    v_add_u32 v11, 4, v4
    v_xor_b32 v11, v11, v9
    v_lshl_add_u32 v23, v11, 4, v10
    v_add_u32 v11, 6, v4
    v_xor_b32 v11, v11, v9
    v_lshl_add_u32 v24, v11, 4, v10
    s_waitcnt lgkmcnt(0)
    s_mov_b32 s24, s8
    s_and_b32 s25, s9, 0xffff
    s_mov_b32 s26, 0x1000000
    s_mov_b32 s27, 0x00020000
    v_add_u32 v26, 0, v20
    v_add_u32 v27, 0, v21
    v_add_u32 v28, 0, v22
    v_add_u32 v29, 0, v23
    v_add_u32 v30, 0, v24
    s_barrier
    ds_read_b128 v[112:115], v27
    ds_read_b64_tr_b16 v[116:117], v26 offset:0
    ds_read_b64_tr_b16 v[118:119], v26 offset:1536
    ds_read_b64_tr_b16 v[120:121], v26 offset:128
    ds_read_b64_tr_b16 v[122:123], v26 offset:1664
    ds_read_b64_tr_b16 v[124:125], v26 offset:256
    ds_read_b64_tr_b16 v[126:127], v26 offset:1792
    ds_read_b128 v[128:131], v28
    ds_read_b64_tr_b16 v[132:133], v26 offset:6144
    ds_read_b64_tr_b16 v[134:135], v26 offset:7680
    ds_read_b64_tr_b16 v[136:137], v26 offset:6272
    ds_read_b64_tr_b16 v[138:139], v26 offset:7808
    ds_read_b64_tr_b16 v[140:141], v26 offset:6400
    ds_read_b64_tr_b16 v[142:143], v26 offset:7936
    s_waitcnt lgkmcnt(7)
    v_mfma_f32_32x32x16_bf16 v[64:79], v[116:119], v[112:115], 0
    ds_read_b128 v[144:147], v29
    ds_read_b64_tr_b16 v[148:149], v26 offset:12288
    ds_read_b64_tr_b16 v[150:151], v26 offset:13824
    v_mfma_f32_32x32x16_bf16 v[80:95], v[120:123], v[112:115], 0
    ds_read_b64_tr_b16 v[152:153], v26 offset:12416
    ds_read_b64_tr_b16 v[154:155], v26 offset:13952
    v_mfma_f32_32x32x16_bf16 v[96:111], v[112:115], v[124:127], 0
    ds_read_b64_tr_b16 v[156:157], v26 offset:12544
    ds_read_b64_tr_b16 v[158:159], v26 offset:14080
    s_waitcnt lgkmcnt(7)
    v_mfma_f32_32x32x16_bf16 v[64:79], v[132:135], v[128:131], v[64:79]
    ds_read_b128 v[112:115], v30
    ds_read_b64_tr_b16 v[116:117], v26 offset:18432
    ds_read_b64_tr_b16 v[118:119], v26 offset:19968
    v_mfma_f32_32x32x16_bf16 v[80:95], v[136:139], v[128:131], v[80:95]
    ds_read_b64_tr_b16 v[120:121], v26 offset:18560
    ds_read_b64_tr_b16 v[122:123], v26 offset:20096
    v_mfma_f32_32x32x16_bf16 v[96:111], v[128:131], v[140:143], v[96:111]
    ds_read_b64_tr_b16 v[124:125], v26 offset:18688
    ds_read_b64_tr_b16 v[126:127], v26 offset:20224
    v_add_u32 v31, 32768, v20
    v_add_u32 v32, 32768, v21
    v_add_u32 v33, 32768, v22
    v_add_u32 v34, 32768, v23
    v_add_u32 v35, 32768, v24
    s_barrier
    s_waitcnt lgkmcnt(7)
    v_mfma_f32_32x32x16_bf16 v[64:79], v[148:151], v[144:147], v[64:79]
    ds_read_b128 v[128:131], v32
    ds_read_b64_tr_b16 v[132:133], v31 offset:0
    ds_read_b64_tr_b16 v[134:135], v31 offset:1536
    v_mfma_f32_32x32x16_bf16 v[80:95], v[152:155], v[144:147], v[80:95]
    ds_read_b64_tr_b16 v[136:137], v31 offset:128
    ds_read_b64_tr_b16 v[138:139], v31 offset:1664
    v_mfma_f32_32x32x16_bf16 v[96:111], v[144:147], v[156:159], v[96:111]
    ds_read_b64_tr_b16 v[140:141], v31 offset:256
    ds_read_b64_tr_b16 v[142:143], v31 offset:1792
    s_waitcnt lgkmcnt(7)
    v_mfma_f32_32x32x16_bf16 v[64:79], v[116:119], v[112:115], v[64:79]
    ds_read_b128 v[144:147], v33
    ds_read_b64_tr_b16 v[148:149], v31 offset:6144
    ds_read_b64_tr_b16 v[150:151], v31 offset:7680
    v_mfma_f32_32x32x16_bf16 v[80:95], v[120:123], v[112:115], v[80:95]
    ds_read_b64_tr_b16 v[152:153], v31 offset:6272
    ds_read_b64_tr_b16 v[154:155], v31 offset:7808
    v_mfma_f32_32x32x16_bf16 v[96:111], v[112:115], v[124:127], v[96:111]
    ds_read_b64_tr_b16 v[156:157], v31 offset:6400
    ds_read_b64_tr_b16 v[158:159], v31 offset:7936
    s_waitcnt lgkmcnt(7)
    v_mfma_f32_32x32x16_bf16 v[64:79], v[132:135], v[128:131], v[64:79]
    ds_read_b128 v[112:115], v34
    ds_read_b64_tr_b16 v[116:117], v31 offset:12288
    ds_read_b64_tr_b16 v[118:119], v31 offset:13824
    v_mfma_f32_32x32x16_bf16 v[80:95], v[136:139], v[128:131], v[80:95]
    ds_read_b64_tr_b16 v[120:121], v31 offset:12416
    ds_read_b64_tr_b16 v[122:123], v31 offset:13952
    v_mfma_f32_32x32x16_bf16 v[96:111], v[128:131], v[140:143], v[96:111]
    ds_read_b64_tr_b16 v[124:125], v31 offset:12544
    ds_read_b64_tr_b16 v[126:127], v31 offset:14080
    s_waitcnt lgkmcnt(7)
    v_mfma_f32_32x32x16_bf16 v[64:79], v[148:151], v[144:147], v[64:79]
    ds_read_b128 v[128:131], v35
    ds_read_b64_tr_b16 v[132:133], v31 offset:18432
    ds_read_b64_tr_b16 v[134:135], v31 offset:19968
    v_mfma_f32_32x32x16_bf16 v[80:95], v[152:155], v[144:147], v[80:95]
    ds_read_b64_tr_b16 v[136:137], v31 offset:18560
    ds_read_b64_tr_b16 v[138:139], v31 offset:20096
    v_mfma_f32_32x32x16_bf16 v[96:111], v[144:147], v[156:159], v[96:111]
    ds_read_b64_tr_b16 v[140:141], v31 offset:18688
    ds_read_b64_tr_b16 v[142:143], v31 offset:20224
    v_add_u32 v26, 65536, v20
    v_add_u32 v27, 65536, v21
    v_add_u32 v28, 65536, v22
    v_add_u32 v29, 65536, v23
    v_add_u32 v30, 65536, v24
    s_barrier
    s_waitcnt lgkmcnt(7)
    v_mfma_f32_32x32x16_bf16 v[64:79], v[116:119], v[112:115], v[64:79]
    ds_read_b128 v[144:147], v27
    ds_read_b64_tr_b16 v[148:149], v26 offset:0
    ds_read_b64_tr_b16 v[150:151], v26 offset:1536
    v_mfma_f32_32x32x16_bf16 v[80:95], v[120:123], v[112:115], v[80:95]
    ds_read_b64_tr_b16 v[152:153], v26 offset:128
    ds_read_b64_tr_b16 v[154:155], v26 offset:1664
    v_mfma_f32_32x32x16_bf16 v[96:111], v[112:115], v[124:127], v[96:111]
    ds_read_b64_tr_b16 v[156:157], v26 offset:256
    ds_read_b64_tr_b16 v[158:159], v26 offset:1792
    s_waitcnt lgkmcnt(7)
    v_mfma_f32_32x32x16_bf16 v[64:79], v[132:135], v[128:131], v[64:79]
    ds_read_b128 v[112:115], v28
    ds_read_b64_tr_b16 v[116:117], v26 offset:6144
    ds_read_b64_tr_b16 v[118:119], v26 offset:7680
    v_mfma_f32_32x32x16_bf16 v[80:95], v[136:139], v[128:131], v[80:95]
    ds_read_b64_tr_b16 v[120:121], v26 offset:6272
    ds_read_b64_tr_b16 v[122:123], v26 offset:7808
    v_mfma_f32_32x32x16_bf16 v[96:111], v[128:131], v[140:143], v[96:111]
    ds_read_b64_tr_b16 v[124:125], v26 offset:6400
    ds_read_b64_tr_b16 v[126:127], v26 offset:7936
    s_waitcnt lgkmcnt(7)
    v_mfma_f32_32x32x16_bf16 v[64:79], v[148:151], v[144:147], v[64:79]
    ds_read_b128 v[128:131], v29
    ds_read_b64_tr_b16 v[132:133], v26 offset:12288
    ds_read_b64_tr_b16 v[134:135], v26 offset:13824
    v_mfma_f32_32x32x16_bf16 v[80:95], v[152:155], v[144:147], v[80:95]
    ds_read_b64_tr_b16 v[136:137], v26 offset:12416
    ds_read_b64_tr_b16 v[138:139], v26 offset:13952
    v_mfma_f32_32x32x16_bf16 v[96:111], v[144:147], v[156:159], v[96:111]
    ds_read_b64_tr_b16 v[140:141], v26 offset:12544
    ds_read_b64_tr_b16 v[142:143], v26 offset:14080
    s_waitcnt lgkmcnt(7)
    v_mfma_f32_32x32x16_bf16 v[64:79], v[116:119], v[112:115], v[64:79]
    ds_read_b128 v[144:147], v30
    ds_read_b64_tr_b16 v[148:149], v26 offset:18432
    ds_read_b64_tr_b16 v[150:151], v26 offset:19968
    v_mfma_f32_32x32x16_bf16 v[80:95], v[120:123], v[112:115], v[80:95]
    ds_read_b64_tr_b16 v[152:153], v26 offset:18560
    ds_read_b64_tr_b16 v[154:155], v26 offset:20096
    v_mfma_f32_32x32x16_bf16 v[96:111], v[112:115], v[124:127], v[96:111]
    ds_read_b64_tr_b16 v[156:157], v26 offset:18688
    ds_read_b64_tr_b16 v[158:159], v26 offset:20224
    v_add_u32 v31, 98304, v20
    v_add_u32 v32, 98304, v21
    v_add_u32 v33, 98304, v22
    v_add_u32 v34, 98304, v23
    v_add_u32 v35, 98304, v24
    s_barrier
    s_waitcnt lgkmcnt(7)
    v_mfma_f32_32x32x16_bf16 v[64:79], v[132:135], v[128:131], v[64:79]
    ds_read_b128 v[112:115], v32
    ds_read_b64_tr_b16 v[116:117], v31 offset:0
    ds_read_b64_tr_b16 v[118:119], v31 offset:1536
    v_mfma_f32_32x32x16_bf16 v[80:95], v[136:139], v[128:131], v[80:95]
    ds_read_b64_tr_b16 v[120:121], v31 offset:128
    ds_read_b64_tr_b16 v[122:123], v31 offset:1664
    v_mfma_f32_32x32x16_bf16 v[96:111], v[128:131], v[140:143], v[96:111]
    ds_read_b64_tr_b16 v[124:125], v31 offset:256
    ds_read_b64_tr_b16 v[126:127], v31 offset:1792
    s_waitcnt lgkmcnt(7)
    v_mfma_f32_32x32x16_bf16 v[64:79], v[148:151], v[144:147], v[64:79]
    ds_read_b128 v[128:131], v33
    ds_read_b64_tr_b16 v[132:133], v31 offset:6144
    ds_read_b64_tr_b16 v[134:135], v31 offset:7680
    v_mfma_f32_32x32x16_bf16 v[80:95], v[152:155], v[144:147], v[80:95]
    ds_read_b64_tr_b16 v[136:137], v31 offset:6272
    ds_read_b64_tr_b16 v[138:139], v31 offset:7808
    v_mfma_f32_32x32x16_bf16 v[96:111], v[144:147], v[156:159], v[96:111]
    ds_read_b64_tr_b16 v[140:141], v31 offset:6400
    ds_read_b64_tr_b16 v[142:143], v31 offset:7936
    s_waitcnt lgkmcnt(7)
    v_mfma_f32_32x32x16_bf16 v[64:79], v[116:119], v[112:115], v[64:79]
    ds_read_b128 v[144:147], v34
    ds_read_b64_tr_b16 v[148:149], v31 offset:12288
    ds_read_b64_tr_b16 v[150:151], v31 offset:13824
    v_mfma_f32_32x32x16_bf16 v[80:95], v[120:123], v[112:115], v[80:95]
    ds_read_b64_tr_b16 v[152:153], v31 offset:12416
    ds_read_b64_tr_b16 v[154:155], v31 offset:13952
    v_mfma_f32_32x32x16_bf16 v[96:111], v[112:115], v[124:127], v[96:111]
    ds_read_b64_tr_b16 v[156:157], v31 offset:12544
    ds_read_b64_tr_b16 v[158:159], v31 offset:14080
    s_waitcnt lgkmcnt(7)
    v_mfma_f32_32x32x16_bf16 v[64:79], v[132:135], v[128:131], v[64:79]
    ds_read_b128 v[112:115], v35
    ds_read_b64_tr_b16 v[116:117], v31 offset:18432
    ds_read_b64_tr_b16 v[118:119], v31 offset:19968
    v_mfma_f32_32x32x16_bf16 v[80:95], v[136:139], v[128:131], v[80:95]
    ds_read_b64_tr_b16 v[120:121], v31 offset:18560
    ds_read_b64_tr_b16 v[122:123], v31 offset:20096
    v_mfma_f32_32x32x16_bf16 v[96:111], v[128:131], v[140:143], v[96:111]
    ds_read_b64_tr_b16 v[124:125], v31 offset:18688
    ds_read_b64_tr_b16 v[126:127], v31 offset:20224
    v_add_u32 v26, 131072, v20
    v_add_u32 v27, 131072, v21
    v_add_u32 v28, 131072, v22
    v_add_u32 v29, 131072, v23
    v_add_u32 v30, 131072, v24
    s_barrier
    s_waitcnt lgkmcnt(7)
    v_mfma_f32_32x32x16_bf16 v[64:79], v[148:151], v[144:147], v[64:79]
    ds_read_b128 v[128:131], v27
    ds_read_b64_tr_b16 v[132:133], v26 offset:0
    ds_read_b64_tr_b16 v[134:135], v26 offset:1536
    v_mfma_f32_32x32x16_bf16 v[80:95], v[152:155], v[144:147], v[80:95]
    ds_read_b64_tr_b16 v[136:137], v26 offset:128
    ds_read_b64_tr_b16 v[138:139], v26 offset:1664
    v_mfma_f32_32x32x16_bf16 v[96:111], v[144:147], v[156:159], v[96:111]
    ds_read_b64_tr_b16 v[140:141], v26 offset:256
    ds_read_b64_tr_b16 v[142:143], v26 offset:1792
    s_waitcnt lgkmcnt(7)
    v_mfma_f32_32x32x16_bf16 v[64:79], v[116:119], v[112:115], v[64:79]
    ds_read_b128 v[144:147], v28
    ds_read_b64_tr_b16 v[148:149], v26 offset:6144
    ds_read_b64_tr_b16 v[150:151], v26 offset:7680
    v_mfma_f32_32x32x16_bf16 v[80:95], v[120:123], v[112:115], v[80:95]
    ds_read_b64_tr_b16 v[152:153], v26 offset:6272
    ds_read_b64_tr_b16 v[154:155], v26 offset:7808
    v_mfma_f32_32x32x16_bf16 v[96:111], v[112:115], v[124:127], v[96:111]
    ds_read_b64_tr_b16 v[156:157], v26 offset:6400
    ds_read_b64_tr_b16 v[158:159], v26 offset:7936
    s_waitcnt lgkmcnt(7)
    v_mfma_f32_32x32x16_bf16 v[64:79], v[132:135], v[128:131], v[64:79]
    ds_read_b128 v[112:115], v29
    ds_read_b64_tr_b16 v[116:117], v26 offset:12288
    ds_read_b64_tr_b16 v[118:119], v26 offset:13824
    v_mfma_f32_32x32x16_bf16 v[80:95], v[136:139], v[128:131], v[80:95]
    ds_read_b64_tr_b16 v[120:121], v26 offset:12416
    ds_read_b64_tr_b16 v[122:123], v26 offset:13952
    v_mfma_f32_32x32x16_bf16 v[96:111], v[128:131], v[140:143], v[96:111]
    ds_read_b64_tr_b16 v[124:125], v26 offset:12544
    ds_read_b64_tr_b16 v[126:127], v26 offset:14080
    s_waitcnt lgkmcnt(7)
    v_mfma_f32_32x32x16_bf16 v[64:79], v[148:151], v[144:147], v[64:79]
    ds_read_b128 v[128:131], v30
    ds_read_b64_tr_b16 v[132:133], v26 offset:18432
    ds_read_b64_tr_b16 v[134:135], v26 offset:19968
    v_mfma_f32_32x32x16_bf16 v[80:95], v[152:155], v[144:147], v[80:95]
    ds_read_b64_tr_b16 v[136:137], v26 offset:18560
    ds_read_b64_tr_b16 v[138:139], v26 offset:20096
    v_mfma_f32_32x32x16_bf16 v[96:111], v[144:147], v[156:159], v[96:111]
    ds_read_b64_tr_b16 v[140:141], v26 offset:18688
    ds_read_b64_tr_b16 v[142:143], v26 offset:20224
    v_add_u32 v31, 0, v20
    v_add_u32 v32, 0, v21
    v_add_u32 v33, 0, v22
    v_add_u32 v34, 0, v23
    v_add_u32 v35, 0, v24
    s_barrier
    s_waitcnt lgkmcnt(7)
    v_mfma_f32_32x32x16_bf16 v[64:79], v[116:119], v[112:115], v[64:79]
    ds_read_b128 v[144:147], v32
    ds_read_b64_tr_b16 v[148:149], v31 offset:0
    ds_read_b64_tr_b16 v[150:151], v31 offset:1536
    v_mfma_f32_32x32x16_bf16 v[80:95], v[120:123], v[112:115], v[80:95]
    ds_read_b64_tr_b16 v[152:153], v31 offset:128
    ds_read_b64_tr_b16 v[154:155], v31 offset:1664
    v_mfma_f32_32x32x16_bf16 v[96:111], v[112:115], v[124:127], v[96:111]
    ds_read_b64_tr_b16 v[156:157], v31 offset:256
    ds_read_b64_tr_b16 v[158:159], v31 offset:1792
    s_waitcnt lgkmcnt(7)
    v_mfma_f32_32x32x16_bf16 v[64:79], v[132:135], v[128:131], v[64:79]
    ds_read_b128 v[112:115], v33
    ds_read_b64_tr_b16 v[116:117], v31 offset:6144
    ds_read_b64_tr_b16 v[118:119], v31 offset:7680
    v_mfma_f32_32x32x16_bf16 v[80:95], v[136:139], v[128:131], v[80:95]
    ds_read_b64_tr_b16 v[120:121], v31 offset:6272
    ds_read_b64_tr_b16 v[122:123], v31 offset:7808
    v_mfma_f32_32x32x16_bf16 v[96:111], v[128:131], v[140:143], v[96:111]
    ds_read_b64_tr_b16 v[124:125], v31 offset:6400
    ds_read_b64_tr_b16 v[126:127], v31 offset:7936
    s_waitcnt lgkmcnt(7)
    v_mfma_f32_32x32x16_bf16 v[64:79], v[148:151], v[144:147], v[64:79]
    ds_read_b128 v[128:131], v34
    ds_read_b64_tr_b16 v[132:133], v31 offset:12288
    ds_read_b64_tr_b16 v[134:135], v31 offset:13824
    v_mfma_f32_32x32x16_bf16 v[80:95], v[152:155], v[144:147], v[80:95]
    ds_read_b64_tr_b16 v[136:137], v31 offset:12416
    ds_read_b64_tr_b16 v[138:139], v31 offset:13952
    v_mfma_f32_32x32x16_bf16 v[96:111], v[144:147], v[156:159], v[96:111]
    ds_read_b64_tr_b16 v[140:141], v31 offset:12544
    ds_read_b64_tr_b16 v[142:143], v31 offset:14080
    s_waitcnt lgkmcnt(7)
    v_mfma_f32_32x32x16_bf16 v[64:79], v[116:119], v[112:115], v[64:79]
    ds_read_b128 v[144:147], v35
    ds_read_b64_tr_b16 v[148:149], v31 offset:18432
    ds_read_b64_tr_b16 v[150:151], v31 offset:19968
    v_mfma_f32_32x32x16_bf16 v[80:95], v[120:123], v[112:115], v[80:95]
    ds_read_b64_tr_b16 v[152:153], v31 offset:18560
    ds_read_b64_tr_b16 v[154:155], v31 offset:20096
    v_mfma_f32_32x32x16_bf16 v[96:111], v[112:115], v[124:127], v[96:111]
    ds_read_b64_tr_b16 v[156:157], v31 offset:18688
    ds_read_b64_tr_b16 v[158:159], v31 offset:20224
    v_add_u32 v26, 32768, v20
    v_add_u32 v27, 32768, v21
    v_add_u32 v28, 32768, v22
    v_add_u32 v29, 32768, v23
    v_add_u32 v30, 32768, v24
    s_barrier
    s_waitcnt lgkmcnt(7)
    v_mfma_f32_32x32x16_bf16 v[64:79], v[132:135], v[128:131], v[64:79]
    ds_read_b128 v[112:115], v27
    ds_read_b64_tr_b16 v[116:117], v26 offset:0
    ds_read_b64_tr_b16 v[118:119], v26 offset:1536
    v_mfma_f32_32x32x16_bf16 v[80:95], v[136:139], v[128:131], v[80:95]
    ds_read_b64_tr_b16 v[120:121], v26 offset:128
    ds_read_b64_tr_b16 v[122:123], v26 offset:1664
    v_mfma_f32_32x32x16_bf16 v[96:111], v[128:131], v[140:143], v[96:111]
    ds_read_b64_tr_b16 v[124:125], v26 offset:256
    ds_read_b64_tr_b16 v[126:127], v26 offset:1792
    s_waitcnt lgkmcnt(7)
    v_mfma_f32_32x32x16_bf16 v[64:79], v[148:151], v[144:147], v[64:79]
    ds_read_b128 v[128:131], v28
    ds_read_b64_tr_b16 v[132:133], v26 offset:6144
    ds_read_b64_tr_b16 v[134:135], v26 offset:7680
    v_mfma_f32_32x32x16_bf16 v[80:95], v[152:155], v[144:147], v[80:95]
    ds_read_b64_tr_b16 v[136:137], v26 offset:6272
    ds_read_b64_tr_b16 v[138:139], v26 offset:7808
    v_mfma_f32_32x32x16_bf16 v[96:111], v[144:147], v[156:159], v[96:111]
    ds_read_b64_tr_b16 v[140:141], v26 offset:6400
    ds_read_b64_tr_b16 v[142:143], v26 offset:7936
    s_waitcnt lgkmcnt(7)
    v_mfma_f32_32x32x16_bf16 v[64:79], v[116:119], v[112:115], v[64:79]
    ds_read_b128 v[144:147], v29
    ds_read_b64_tr_b16 v[148:149], v26 offset:12288
    ds_read_b64_tr_b16 v[150:151], v26 offset:13824
    v_mfma_f32_32x32x16_bf16 v[80:95], v[120:123], v[112:115], v[80:95]
    ds_read_b64_tr_b16 v[152:153], v26 offset:12416
    ds_read_b64_tr_b16 v[154:155], v26 offset:13952
    v_mfma_f32_32x32x16_bf16 v[96:111], v[112:115], v[124:127], v[96:111]
    ds_read_b64_tr_b16 v[156:157], v26 offset:12544
    ds_read_b64_tr_b16 v[158:159], v26 offset:14080
    s_waitcnt lgkmcnt(7)
    v_mfma_f32_32x32x16_bf16 v[64:79], v[132:135], v[128:131], v[64:79]
    ds_read_b128 v[112:115], v30
    ds_read_b64_tr_b16 v[116:117], v26 offset:18432
    ds_read_b64_tr_b16 v[118:119], v26 offset:19968
    v_mfma_f32_32x32x16_bf16 v[80:95], v[136:139], v[128:131], v[80:95]
    ds_read_b64_tr_b16 v[120:121], v26 offset:18560
    ds_read_b64_tr_b16 v[122:123], v26 offset:20096
    v_mfma_f32_32x32x16_bf16 v[96:111], v[128:131], v[140:143], v[96:111]
    ds_read_b64_tr_b16 v[124:125], v26 offset:18688
    ds_read_b64_tr_b16 v[126:127], v26 offset:20224
    v_add_u32 v31, 65536, v20
    v_add_u32 v32, 65536, v21
    v_add_u32 v33, 65536, v22
    v_add_u32 v34, 65536, v23
    v_add_u32 v35, 65536, v24
    s_barrier
    s_waitcnt lgkmcnt(7)
    v_mfma_f32_32x32x16_bf16 v[64:79], v[148:151], v[144:147], v[64:79]
    ds_read_b128 v[128:131], v32
    ds_read_b64_tr_b16 v[132:133], v31 offset:0
    ds_read_b64_tr_b16 v[134:135], v31 offset:1536
    v_mfma_f32_32x32x16_bf16 v[80:95], v[152:155], v[144:147], v[80:95]
    ds_read_b64_tr_b16 v[136:137], v31 offset:128
    ds_read_b64_tr_b16 v[138:139], v31 offset:1664
    v_mfma_f32_32x32x16_bf16 v[96:111], v[144:147], v[156:159], v[96:111]
    ds_read_b64_tr_b16 v[140:141], v31 offset:256
    ds_read_b64_tr_b16 v[142:143], v31 offset:1792
    s_waitcnt lgkmcnt(7)
    v_mfma_f32_32x32x16_bf16 v[64:79], v[116:119], v[112:115], v[64:79]
    ds_read_b128 v[144:147], v33
    ds_read_b64_tr_b16 v[148:149], v31 offset:6144
    ds_read_b64_tr_b16 v[150:151], v31 offset:7680
    v_mfma_f32_32x32x16_bf16 v[80:95], v[120:123], v[112:115], v[80:95]
    ds_read_b64_tr_b16 v[152:153], v31 offset:6272
    ds_read_b64_tr_b16 v[154:155], v31 offset:7808
    v_mfma_f32_32x32x16_bf16 v[96:111], v[112:115], v[124:127], v[96:111]
    ds_read_b64_tr_b16 v[156:157], v31 offset:6400
    ds_read_b64_tr_b16 v[158:159], v31 offset:7936
    s_waitcnt lgkmcnt(7)
    v_mfma_f32_32x32x16_bf16 v[64:79], v[132:135], v[128:131], v[64:79]
    ds_read_b128 v[112:115], v34
    ds_read_b64_tr_b16 v[116:117], v31 offset:12288
    ds_read_b64_tr_b16 v[118:119], v31 offset:13824
    v_mfma_f32_32x32x16_bf16 v[80:95], v[136:139], v[128:131], v[80:95]
    ds_read_b64_tr_b16 v[120:121], v31 offset:12416
    ds_read_b64_tr_b16 v[122:123], v31 offset:13952
    v_mfma_f32_32x32x16_bf16 v[96:111], v[128:131], v[140:143], v[96:111]
    ds_read_b64_tr_b16 v[124:125], v31 offset:12544
    ds_read_b64_tr_b16 v[126:127], v31 offset:14080
    s_waitcnt lgkmcnt(7)
    v_mfma_f32_32x32x16_bf16 v[64:79], v[148:151], v[144:147], v[64:79]
    ds_read_b128 v[128:131], v35
    ds_read_b64_tr_b16 v[132:133], v31 offset:18432
    ds_read_b64_tr_b16 v[134:135], v31 offset:19968
    v_mfma_f32_32x32x16_bf16 v[80:95], v[152:155], v[144:147], v[80:95]
    ds_read_b64_tr_b16 v[136:137], v31 offset:18560
    ds_read_b64_tr_b16 v[138:139], v31 offset:20096
    v_mfma_f32_32x32x16_bf16 v[96:111], v[144:147], v[156:159], v[96:111]
    ds_read_b64_tr_b16 v[140:141], v31 offset:18688
    ds_read_b64_tr_b16 v[142:143], v31 offset:20224
    s_waitcnt lgkmcnt(7)
    v_mfma_f32_32x32x16_bf16 v[64:79], v[116:119], v[112:115], v[64:79]
    v_mfma_f32_32x32x16_bf16 v[80:95], v[120:123], v[112:115], v[80:95]
    v_mfma_f32_32x32x16_bf16 v[96:111], v[112:115], v[124:127], v[96:111]
    s_waitcnt lgkmcnt(0)
    v_mfma_f32_32x32x16_bf16 v[64:79], v[132:135], v[128:131], v[64:79]
    v_mfma_f32_32x32x16_bf16 v[80:95], v[136:139], v[128:131], v[80:95]
    v_mfma_f32_32x32x16_bf16 v[96:111], v[128:131], v[140:143], v[96:111]
    v_lshlrev_b32 v5, 4, v2
    s_lshl_b32 s30, s12, 1
    s_add_u32 s30, s30, s29
    s_lshl_b32 s30, s30, 17
    s_lshl_b32 s31, s13, 1
    s_add_u32 s31, s31, s28
    s_lshl_b32 s31, s31, 10
    s_add_u32 s30, s30, s31
    s_add_u32 s31, s30, 0x10000
    s_add_u32 s32, s30, 0x200000
    s_add_u32 s33, s31, 0x200000
    v_lshrrev_b32 v9, 4, v3
    v_lshlrev_b32 v6, 16, v9
    v_lshl_add_u32 v6, v4, 8, v6
    v_and_b32 v9, 15, v3
    v_lshl_add_u32 v6, v9, 4, v6
    s_add_u32 s34, s30, 0x400000
    s_nop 7
    v_cvt_pk_bf16_f32 v8, v64, v65
    v_cvt_pk_bf16_f32 v9, v66, v67
    v_cvt_pk_bf16_f32 v10, v68, v69
    v_cvt_pk_bf16_f32 v11, v70, v71
    v_cvt_pk_bf16_f32 v12, v72, v73
    v_cvt_pk_bf16_f32 v13, v74, v75
    v_cvt_pk_bf16_f32 v14, v76, v77
    v_cvt_pk_bf16_f32 v15, v78, v79
    v_cvt_pk_bf16_f32 v16, v80, v81
    v_cvt_pk_bf16_f32 v17, v82, v83
    v_cvt_pk_bf16_f32 v18, v84, v85
    v_cvt_pk_bf16_f32 v19, v86, v87
    v_cvt_pk_bf16_f32 v20, v88, v89
    v_cvt_pk_bf16_f32 v21, v90, v91
    v_cvt_pk_bf16_f32 v22, v92, v93
    v_cvt_pk_bf16_f32 v23, v94, v95
    v_cvt_pk_bf16_f32 v24, v96, v97
    v_cvt_pk_bf16_f32 v25, v98, v99
    v_cvt_pk_bf16_f32 v26, v100, v101
    v_cvt_pk_bf16_f32 v27, v102, v103
    v_cvt_pk_bf16_f32 v28, v104, v105
    v_cvt_pk_bf16_f32 v29, v106, v107
    v_cvt_pk_bf16_f32 v30, v108, v109
    v_cvt_pk_bf16_f32 v31, v110, v111
    buffer_store_dwordx4 v[8:11], v5, s[24:27], s30 offen sc1
    buffer_store_dwordx4 v[12:15], v5, s[24:27], s31 offen sc1
    buffer_store_dwordx4 v[16:19], v5, s[24:27], s32 offen sc1
    buffer_store_dwordx4 v[20:23], v5, s[24:27], s33 offen sc1
    buffer_store_dwordx4 v[24:27], v6, s[24:27], s34 offen sc1
    buffer_store_dwordx4 v[28:31], v6, s[24:27], s34 offen offset:512 sc1
    s_endpgm
L_k1_loader:
    s_sub_u32 s14, s39, 4
    s_mul_i32 s28, s14, 16
    s_add_u32 s30, s15, s28
    v_lshrrev_b32 v9, 3, v2
    v_add_u32 v9, s30, v9
    v_lshlrev_b32 v9, 10, v9
    v_and_b32 v10, 7, v2
    v_lshrrev_b32 v11, 4, v2
    s_lshr_b32 s30, s28, 1
    v_add_u32 v11, s30, v11
    v_add_u32 v12, 0, v11
    v_and_b32 v12, 7, v12
    v_xor_b32 v12, v12, v10
    v_lshl_add_u32 v12, v12, 4, v9
    v_add_u32 v16, 0, v12
    v_add_u32 v12, 4, v11
    v_and_b32 v12, 7, v12
    v_xor_b32 v12, v12, v10
    v_lshl_add_u32 v12, v12, 4, v9
    v_add_u32 v17, 7168, v12
    s_lshl_b32 s29, s12, 7
    v_add_u32 v9, 0, v2
    v_mul_u32_u24 v10, 0xaaab, v9
    v_lshrrev_b32 v10, 20, v10
    v_mul_u32_u24 v11, 24, v10
    v_sub_u32 v11, v9, v11
    v_lshrrev_b32 v12, 3, v11
    v_and_b32 v11, 7, v11
    v_bfe_u32 v13, v10, 1, 1
    v_lshlrev_b32 v13, 2, v13
    v_xor_b32 v11, v11, v13
    v_mul_u32_u24 v10, 0xc00, v10
    v_lshl_add_u32 v10, v12, 10, v10
    v_lshl_add_u32 v10, v11, 4, v10
    v_add_u32 v10, s29, v10
    v_mov_b32 v6, v10
    v_add_u32 v9, 64, v2
    v_mul_u32_u24 v10, 0xaaab, v9
    v_lshrrev_b32 v10, 20, v10
    v_mul_u32_u24 v11, 24, v10
    v_sub_u32 v11, v9, v11
    v_lshrrev_b32 v12, 3, v11
    v_and_b32 v11, 7, v11
    v_bfe_u32 v13, v10, 1, 1
    v_lshlrev_b32 v13, 2, v13
    v_xor_b32 v11, v11, v13
    v_mul_u32_u24 v10, 0xc00, v10
    v_lshl_add_u32 v10, v12, 10, v10
    v_lshl_add_u32 v10, v11, 4, v10
    v_add_u32 v10, s29, v10
    v_subrev_u32 v7, 1024, v10
    v_add_u32 v9, 128, v2
    v_mul_u32_u24 v10, 0xaaab, v9
    v_lshrrev_b32 v10, 20, v10
    v_mul_u32_u24 v11, 24, v10
    v_sub_u32 v11, v9, v11
    v_lshrrev_b32 v12, 3, v11
    v_and_b32 v11, 7, v11
    v_bfe_u32 v13, v10, 1, 1
    v_lshlrev_b32 v13, 2, v13
    v_xor_b32 v11, v11, v13
    v_mul_u32_u24 v10, 0xc00, v10
    v_lshl_add_u32 v10, v12, 10, v10
    v_lshl_add_u32 v10, v11, 4, v10
    v_add_u32 v10, s29, v10
    v_subrev_u32 v8, 2048, v10
    s_waitcnt lgkmcnt(0)
    s_mov_b32 s16, s4
    s_and_b32 s17, s5, 0xffff
    s_mov_b32 s18, 0x200000
    s_mov_b32 s19, 0x00020000
    s_mov_b32 s20, s6
    s_and_b32 s21, s7, 0xffff
    s_mov_b32 s22, 0x180000
    s_mov_b32 s23, 0x00020000
    s_lshl_b32 s36, s28, 7
    s_mul_i32 s37, s28, 384
    s_add_u32 s37, s37, 0x2000
    s_mul_i32 s38, s28, 0xc00
    s_lshl_b32 s43, s12, 1
    s_add_u32 s43, s43, s13
    s_add_u32 s30, s36, 0
    s_mov_b32 m0, s30
    s_add_u32 s44, s43, 0
    s_and_b32 s44, s44, 7
    s_lshl_b32 s31, s44, 7
    buffer_load_dwordx4 v16, s[16:19], s31 offen offset:0 lds
    buffer_load_dwordx4 v17, s[16:19], s31 offen offset:1024 lds
    s_mul_i32 s44, s44, 196608
    s_add_u32 s44, s44, s38
    s_add_u32 s30, s37, 0
    s_mov_b32 m0, s30
    s_add_u32 s31, s44, 0
    buffer_load_dwordx4 v6, s[20:23], s31 offen offset:0 lds
    buffer_load_dwordx4 v7, s[20:23], s31 offen offset:1024 lds
    buffer_load_dwordx4 v8, s[20:23], s31 offen offset:2048 lds
    s_add_u32 s30, s37, 3072
    s_mov_b32 m0, s30
    s_add_u32 s31, s44, 24576
    buffer_load_dwordx4 v6, s[20:23], s31 offen offset:0 lds
    buffer_load_dwordx4 v7, s[20:23], s31 offen offset:1024 lds
    buffer_load_dwordx4 v8, s[20:23], s31 offen offset:2048 lds
    s_add_u32 s30, s36, 32768
    s_mov_b32 m0, s30
    s_add_u32 s44, s43, 1
    s_and_b32 s44, s44, 7
    s_lshl_b32 s31, s44, 7
    buffer_load_dwordx4 v16, s[16:19], s31 offen offset:0 lds
    buffer_load_dwordx4 v17, s[16:19], s31 offen offset:1024 lds
    s_mul_i32 s44, s44, 196608
    s_add_u32 s44, s44, s38
    s_add_u32 s30, s37, 32768
    s_mov_b32 m0, s30
    s_add_u32 s31, s44, 0
    buffer_load_dwordx4 v6, s[20:23], s31 offen offset:0 lds
    buffer_load_dwordx4 v7, s[20:23], s31 offen offset:1024 lds
    buffer_load_dwordx4 v8, s[20:23], s31 offen offset:2048 lds
    s_add_u32 s30, s37, 35840
    s_mov_b32 m0, s30
    s_add_u32 s31, s44, 24576
    buffer_load_dwordx4 v6, s[20:23], s31 offen offset:0 lds
    buffer_load_dwordx4 v7, s[20:23], s31 offen offset:1024 lds
    buffer_load_dwordx4 v8, s[20:23], s31 offen offset:2048 lds
    s_waitcnt vmcnt(8)
    s_barrier
    s_add_u32 s30, s36, 65536
    s_mov_b32 m0, s30
    s_add_u32 s44, s43, 2
    s_and_b32 s44, s44, 7
    s_lshl_b32 s31, s44, 7
    buffer_load_dwordx4 v16, s[16:19], s31 offen offset:0 lds
    buffer_load_dwordx4 v17, s[16:19], s31 offen offset:1024 lds
    s_mul_i32 s44, s44, 196608
    s_add_u32 s44, s44, s38
    s_add_u32 s30, s37, 65536
    s_mov_b32 m0, s30
    s_add_u32 s31, s44, 0
    buffer_load_dwordx4 v6, s[20:23], s31 offen offset:0 lds
    buffer_load_dwordx4 v7, s[20:23], s31 offen offset:1024 lds
    buffer_load_dwordx4 v8, s[20:23], s31 offen offset:2048 lds
    s_add_u32 s30, s37, 68608
    s_mov_b32 m0, s30
    s_add_u32 s31, s44, 24576
    buffer_load_dwordx4 v6, s[20:23], s31 offen offset:0 lds
    buffer_load_dwordx4 v7, s[20:23], s31 offen offset:1024 lds
    buffer_load_dwordx4 v8, s[20:23], s31 offen offset:2048 lds
    s_waitcnt vmcnt(8)
    s_barrier
    s_add_u32 s30, s36, 98304
    s_mov_b32 m0, s30
    s_add_u32 s44, s43, 3
    s_and_b32 s44, s44, 7
    s_lshl_b32 s31, s44, 7
    buffer_load_dwordx4 v16, s[16:19], s31 offen offset:0 lds
    buffer_load_dwordx4 v17, s[16:19], s31 offen offset:1024 lds
    s_mul_i32 s44, s44, 196608
    s_add_u32 s44, s44, s38
    s_add_u32 s30, s37, 98304
    s_mov_b32 m0, s30
    s_add_u32 s31, s44, 0
    buffer_load_dwordx4 v6, s[20:23], s31 offen offset:0 lds
    buffer_load_dwordx4 v7, s[20:23], s31 offen offset:1024 lds
    buffer_load_dwordx4 v8, s[20:23], s31 offen offset:2048 lds
    s_add_u32 s30, s37, 101376
    s_mov_b32 m0, s30
    s_add_u32 s31, s44, 24576
    buffer_load_dwordx4 v6, s[20:23], s31 offen offset:0 lds
    buffer_load_dwordx4 v7, s[20:23], s31 offen offset:1024 lds
    buffer_load_dwordx4 v8, s[20:23], s31 offen offset:2048 lds
    s_waitcnt vmcnt(8)
    s_barrier
    s_add_u32 s30, s36, 131072
    s_mov_b32 m0, s30
    s_add_u32 s44, s43, 4
    s_and_b32 s44, s44, 7
    s_lshl_b32 s31, s44, 7
    buffer_load_dwordx4 v16, s[16:19], s31 offen offset:0 lds
    buffer_load_dwordx4 v17, s[16:19], s31 offen offset:1024 lds
    s_mul_i32 s44, s44, 196608
    s_add_u32 s44, s44, s38
    s_add_u32 s30, s37, 131072
    s_mov_b32 m0, s30
    s_add_u32 s31, s44, 0
    buffer_load_dwordx4 v6, s[20:23], s31 offen offset:0 lds
    buffer_load_dwordx4 v7, s[20:23], s31 offen offset:1024 lds
    buffer_load_dwordx4 v8, s[20:23], s31 offen offset:2048 lds
    s_add_u32 s30, s37, 134144
    s_mov_b32 m0, s30
    s_add_u32 s31, s44, 24576
    buffer_load_dwordx4 v6, s[20:23], s31 offen offset:0 lds
    buffer_load_dwordx4 v7, s[20:23], s31 offen offset:1024 lds
    buffer_load_dwordx4 v8, s[20:23], s31 offen offset:2048 lds
    s_waitcnt vmcnt(8)
    s_barrier
    s_add_u32 s30, s36, 0
    s_mov_b32 m0, s30
    s_add_u32 s44, s43, 5
    s_and_b32 s44, s44, 7
    s_lshl_b32 s31, s44, 7
    buffer_load_dwordx4 v16, s[16:19], s31 offen offset:0 lds
    buffer_load_dwordx4 v17, s[16:19], s31 offen offset:1024 lds
    s_mul_i32 s44, s44, 196608
    s_add_u32 s44, s44, s38
    s_add_u32 s30, s37, 0
    s_mov_b32 m0, s30
    s_add_u32 s31, s44, 0
    buffer_load_dwordx4 v6, s[20:23], s31 offen offset:0 lds
    buffer_load_dwordx4 v7, s[20:23], s31 offen offset:1024 lds
    buffer_load_dwordx4 v8, s[20:23], s31 offen offset:2048 lds
    s_add_u32 s30, s37, 3072
    s_mov_b32 m0, s30
    s_add_u32 s31, s44, 24576
    buffer_load_dwordx4 v6, s[20:23], s31 offen offset:0 lds
    buffer_load_dwordx4 v7, s[20:23], s31 offen offset:1024 lds
    buffer_load_dwordx4 v8, s[20:23], s31 offen offset:2048 lds
    s_waitcnt vmcnt(8)
    s_barrier
    s_add_u32 s30, s36, 32768
    s_mov_b32 m0, s30
    s_add_u32 s44, s43, 6
    s_and_b32 s44, s44, 7
    s_lshl_b32 s31, s44, 7
    buffer_load_dwordx4 v16, s[16:19], s31 offen offset:0 lds
    buffer_load_dwordx4 v17, s[16:19], s31 offen offset:1024 lds
    s_mul_i32 s44, s44, 196608
    s_add_u32 s44, s44, s38
    s_add_u32 s30, s37, 32768
    s_mov_b32 m0, s30
    s_add_u32 s31, s44, 0
    buffer_load_dwordx4 v6, s[20:23], s31 offen offset:0 lds
    buffer_load_dwordx4 v7, s[20:23], s31 offen offset:1024 lds
    buffer_load_dwordx4 v8, s[20:23], s31 offen offset:2048 lds
    s_add_u32 s30, s37, 35840
    s_mov_b32 m0, s30
    s_add_u32 s31, s44, 24576
    buffer_load_dwordx4 v6, s[20:23], s31 offen offset:0 lds
    buffer_load_dwordx4 v7, s[20:23], s31 offen offset:1024 lds
    buffer_load_dwordx4 v8, s[20:23], s31 offen offset:2048 lds
    s_waitcnt vmcnt(8)
    s_barrier
    s_add_u32 s30, s36, 65536
    s_mov_b32 m0, s30
    s_add_u32 s44, s43, 7
    s_and_b32 s44, s44, 7
    s_lshl_b32 s31, s44, 7
    buffer_load_dwordx4 v16, s[16:19], s31 offen offset:0 lds
    buffer_load_dwordx4 v17, s[16:19], s31 offen offset:1024 lds
    s_mul_i32 s44, s44, 196608
    s_add_u32 s44, s44, s38
    s_add_u32 s30, s37, 65536
    s_mov_b32 m0, s30
    s_add_u32 s31, s44, 0
    buffer_load_dwordx4 v6, s[20:23], s31 offen offset:0 lds
    buffer_load_dwordx4 v7, s[20:23], s31 offen offset:1024 lds
    buffer_load_dwordx4 v8, s[20:23], s31 offen offset:2048 lds
    s_add_u32 s30, s37, 68608
    s_mov_b32 m0, s30
    s_add_u32 s31, s44, 24576
    buffer_load_dwordx4 v6, s[20:23], s31 offen offset:0 lds
    buffer_load_dwordx4 v7, s[20:23], s31 offen offset:1024 lds
    buffer_load_dwordx4 v8, s[20:23], s31 offen offset:2048 lds
    s_waitcnt vmcnt(8)
    s_barrier
    s_waitcnt vmcnt(0)
    s_barrier
L_k1_end:
    s_endpgm

.globl attn_kernel
.p2align 8
.type attn_kernel,@function
attn_kernel:
    s_cmp_ge_u32 s2, 256
    s_cbranch_scc1 L_k2_end
    s_load_dwordx2 s[8:9], s[0:1], 40
    s_load_dwordx2 s[4:5], s[0:1], 16
    s_and_b32 s10, s2, 7
    s_lshr_b32 s11, s2, 3
    s_mov_b32 s64, s11
    s_and_b32 s12, s10, 1
    s_lshl_b32 s12, s12, 4
    s_and_b32 s13, s11, 15
    s_add_u32 s12, s12, s13
    s_lshr_b32 s11, s11, 4
    s_and_b32 s13, s10, 6
    s_add_u32 s11, s11, s13
    v_lshrrev_b32 v1, 6, v0
    v_and_b32 v2, 63, v0
    v_readfirstlane_b32 s14, v1
    v_and_b32 v3, 31, v2
    v_lshrrev_b32 v4, 5, v2
    s_lshl_b32 s13, s11, 3
    s_add_u32 s13, s13, s14
    v_lshlrev_b32 v5, 4, v2
    s_lshl_b32 s15, s12, 16
    s_lshl_b32 s16, s13, 10
    s_add_u32 s16, s16, s15
    s_lshl_b32 s17, s11, 3
    s_lshl_b32 s18, s14, 1
    s_add_u32 s17, s17, s18
    s_sub_u32 s17, s17, 8
    s_max_i32 s17, s17, 0
    s_lshl_b32 s19, s17, 10
    s_add_u32 s19, s19, s15
    s_add_u32 s20, s19, 0x200000
    s_add_u32 s21, s19, 0x400000
    s_lshl_b32 s22, s14, 11
    s_add_u32 s23, s22, 0x4000
    s_waitcnt lgkmcnt(0)
    s_mov_b32 s24, s8
    s_and_b32 s25, s9, 0xffff
    s_mov_b32 s26, 0x1000000
    s_mov_b32 s27, 0x00020000
    buffer_load_dwordx4 v[212:215], v5, s[24:27], s16 offen
    s_mov_b32 m0, s22
    s_nop 0
    buffer_load_dwordx4 v5, s[24:27], s20 offen lds
    buffer_load_dwordx4 v5, s[24:27], s20 offen offset:1024 lds
    s_mov_b32 m0, s23
    s_nop 0
    buffer_load_dwordx4 v5, s[24:27], s21 offen lds
    buffer_load_dwordx4 v5, s[24:27], s21 offen offset:1024 lds
    v_mov_b32 v8, 0x3f803f80
    v_mov_b32 v9, 0x3f803f80
    v_mov_b32 v10, 0x8000
    ds_write_b64 v10, v[8:9]
    ds_write_b64 v10, v[8:9] offset:8
    s_lshl_b32 s18, s14, 10
    v_add_u32 v6, s18, v5
    v_lshlrev_b32 v7, 8, v4
    v_lshl_add_u32 v7, v3, 4, v7
    v_add_u32 v7, s18, v7
    v_add_u32 v7, 0x4000, v7
    v_cmp_gt_u32 vcc, 16, v3
    v_mov_b32 v11, 0x200
    s_nop 0
    v_cndmask_b32 v7, v10, v7, vcc
    v_cndmask_b32 v14, 0, v11, vcc
    s_add_u32 s17, s16, 0x800000
    v_lshlrev_b32 v8, 2, v4
    v_sub_u32 v8, v3, v8
    v_cmp_le_i32 s[32:33], 0, v8
    v_cmp_le_i32 s[34:35], 1, v8
    v_cmp_le_i32 s[36:37], 2, v8
    v_cmp_le_i32 s[38:39], 3, v8
    v_cmp_le_i32 s[40:41], 8, v8
    v_cmp_le_i32 s[42:43], 9, v8
    v_cmp_le_i32 s[44:45], 10, v8
    v_cmp_le_i32 s[46:47], 11, v8
    v_cmp_le_i32 s[48:49], 16, v8
    v_cmp_le_i32 s[50:51], 17, v8
    v_cmp_le_i32 s[52:53], 18, v8
    v_cmp_le_i32 s[54:55], 19, v8
    v_cmp_le_i32 s[56:57], 24, v8
    v_cmp_le_i32 s[58:59], 25, v8
    v_cmp_le_i32 s[60:61], 26, v8
    v_cmp_le_i32 s[62:63], 27, v8
    v_mov_b32 v15, 0x3eb8aa3b
    v_mov_b32 v240, 0x3eb8aa3b
    v_mov_b32 v241, 0x3eb8aa3b
    v_mov_b32 v8, 0xffff
    v_mov_b32 v9, 0xffff0000
    v_cndmask_b32 v232, 0, v8, s[32:33]
    v_cndmask_b32 v11, 0, v9, s[34:35]
    v_or_b32 v232, v232, v11
    v_cndmask_b32 v233, 0, v8, s[36:37]
    v_cndmask_b32 v11, 0, v9, s[38:39]
    v_or_b32 v233, v233, v11
    v_cndmask_b32 v234, 0, v8, s[40:41]
    v_cndmask_b32 v11, 0, v9, s[42:43]
    v_or_b32 v234, v234, v11
    v_cndmask_b32 v235, 0, v8, s[44:45]
    v_cndmask_b32 v11, 0, v9, s[46:47]
    v_or_b32 v235, v235, v11
    v_cndmask_b32 v236, 0, v8, s[48:49]
    v_cndmask_b32 v11, 0, v9, s[50:51]
    v_or_b32 v236, v236, v11
    v_cndmask_b32 v237, 0, v8, s[52:53]
    v_cndmask_b32 v11, 0, v9, s[54:55]
    v_or_b32 v237, v237, v11
    v_cndmask_b32 v238, 0, v8, s[56:57]
    v_cndmask_b32 v11, 0, v9, s[58:59]
    v_or_b32 v238, v238, v11
    v_cndmask_b32 v239, 0, v8, s[60:61]
    v_cndmask_b32 v11, 0, v9, s[62:63]
    v_or_b32 v239, v239, v11
    s_mov_b32 s28, s4
    s_and_b32 s29, s5, 0xffff
    s_mov_b32 s30, 0x80000
    s_mov_b32 s31, 0x00020000
    s_lshl_b32 s64, s64, 3
    s_add_u32 s64, s64, s14
    s_lshl_b32 s64, s64, 11
    v_lshlrev_b32 v253, 5, v2
    s_waitcnt vmcnt(0) lgkmcnt(0)
    s_barrier
    buffer_load_dword v252, v253, s[28:31], s64 offen
    ds_read_b128 v[160:163], v6 offset:0
    ds_read_b128 v[164:167], v6 offset:1024
    ds_read_b128 v[168:171], v6 offset:2048
    ds_read_b128 v[172:175], v6 offset:3072
    ds_read_b128 v[176:179], v6 offset:4096
    ds_read_b128 v[180:183], v6 offset:5120
    ds_read_b128 v[184:187], v6 offset:6144
    ds_read_b128 v[188:191], v6 offset:7168
    ds_read_b128 v[192:195], v6 offset:8192
    s_waitcnt lgkmcnt(8)
    v_mfma_f32_32x32x16_bf16 v[16:31], v[160:163], v[212:215], 0
    s_waitcnt lgkmcnt(7)
    v_mfma_f32_32x32x16_bf16 v[32:47], v[164:167], v[212:215], 0
    s_waitcnt lgkmcnt(6)
    v_mfma_f32_32x32x16_bf16 v[48:63], v[168:171], v[212:215], 0
    s_waitcnt lgkmcnt(5)
    v_mfma_f32_32x32x16_bf16 v[64:79], v[172:175], v[212:215], 0
    s_waitcnt lgkmcnt(4)
    v_mfma_f32_32x32x16_bf16 v[80:95], v[176:179], v[212:215], 0
    s_waitcnt lgkmcnt(3)
    v_mfma_f32_32x32x16_bf16 v[96:111], v[180:183], v[212:215], 0
    s_waitcnt lgkmcnt(2)
    v_mfma_f32_32x32x16_bf16 v[112:127], v[184:187], v[212:215], 0
    s_waitcnt lgkmcnt(1)
    v_mfma_f32_32x32x16_bf16 v[128:143], v[188:191], v[212:215], 0
    s_waitcnt lgkmcnt(0)
    v_mfma_f32_32x32x16_bf16 v[144:159], v[192:195], v[212:215], 0
    s_nop 7
    s_nop 4
    s_cmp_ge_u32 s13, 8
    s_cbranch_scc1 L_k2_fix_done
    v_mov_b32 v9, 0xcf800000
    v_mov_b32 v16, v9
    v_mov_b32 v17, v9
    v_mov_b32 v18, v9
    v_mov_b32 v19, v9
    v_mov_b32 v20, v9
    v_mov_b32 v21, v9
    v_mov_b32 v22, v9
    v_mov_b32 v23, v9
    v_mov_b32 v24, v9
    v_mov_b32 v25, v9
    v_mov_b32 v26, v9
    v_mov_b32 v27, v9
    v_mov_b32 v28, v9
    v_mov_b32 v29, v9
    v_mov_b32 v30, v9
    v_mov_b32 v31, v9
    s_cmp_ge_u32 s13, 7
    s_cbranch_scc1 L_k2_fix_done
    v_mov_b32 v32, v9
    v_mov_b32 v33, v9
    v_mov_b32 v34, v9
    v_mov_b32 v35, v9
    v_mov_b32 v36, v9
    v_mov_b32 v37, v9
    v_mov_b32 v38, v9
    v_mov_b32 v39, v9
    v_mov_b32 v40, v9
    v_mov_b32 v41, v9
    v_mov_b32 v42, v9
    v_mov_b32 v43, v9
    v_mov_b32 v44, v9
    v_mov_b32 v45, v9
    v_mov_b32 v46, v9
    v_mov_b32 v47, v9
    s_cmp_ge_u32 s13, 6
    s_cbranch_scc1 L_k2_fix_done
    v_mov_b32 v48, v9
    v_mov_b32 v49, v9
    v_mov_b32 v50, v9
    v_mov_b32 v51, v9
    v_mov_b32 v52, v9
    v_mov_b32 v53, v9
    v_mov_b32 v54, v9
    v_mov_b32 v55, v9
    v_mov_b32 v56, v9
    v_mov_b32 v57, v9
    v_mov_b32 v58, v9
    v_mov_b32 v59, v9
    v_mov_b32 v60, v9
    v_mov_b32 v61, v9
    v_mov_b32 v62, v9
    v_mov_b32 v63, v9
    s_cmp_ge_u32 s13, 5
    s_cbranch_scc1 L_k2_fix_done
    v_mov_b32 v64, v9
    v_mov_b32 v65, v9
    v_mov_b32 v66, v9
    v_mov_b32 v67, v9
    v_mov_b32 v68, v9
    v_mov_b32 v69, v9
    v_mov_b32 v70, v9
    v_mov_b32 v71, v9
    v_mov_b32 v72, v9
    v_mov_b32 v73, v9
    v_mov_b32 v74, v9
    v_mov_b32 v75, v9
    v_mov_b32 v76, v9
    v_mov_b32 v77, v9
    v_mov_b32 v78, v9
    v_mov_b32 v79, v9
    s_cmp_ge_u32 s13, 4
    s_cbranch_scc1 L_k2_fix_done
    v_mov_b32 v80, v9
    v_mov_b32 v81, v9
    v_mov_b32 v82, v9
    v_mov_b32 v83, v9
    v_mov_b32 v84, v9
    v_mov_b32 v85, v9
    v_mov_b32 v86, v9
    v_mov_b32 v87, v9
    v_mov_b32 v88, v9
    v_mov_b32 v89, v9
    v_mov_b32 v90, v9
    v_mov_b32 v91, v9
    v_mov_b32 v92, v9
    v_mov_b32 v93, v9
    v_mov_b32 v94, v9
    v_mov_b32 v95, v9
    s_cmp_ge_u32 s13, 3
    s_cbranch_scc1 L_k2_fix_done
    v_mov_b32 v96, v9
    v_mov_b32 v97, v9
    v_mov_b32 v98, v9
    v_mov_b32 v99, v9
    v_mov_b32 v100, v9
    v_mov_b32 v101, v9
    v_mov_b32 v102, v9
    v_mov_b32 v103, v9
    v_mov_b32 v104, v9
    v_mov_b32 v105, v9
    v_mov_b32 v106, v9
    v_mov_b32 v107, v9
    v_mov_b32 v108, v9
    v_mov_b32 v109, v9
    v_mov_b32 v110, v9
    v_mov_b32 v111, v9
    s_cmp_ge_u32 s13, 2
    s_cbranch_scc1 L_k2_fix_done
    v_mov_b32 v112, v9
    v_mov_b32 v113, v9
    v_mov_b32 v114, v9
    v_mov_b32 v115, v9
    v_mov_b32 v116, v9
    v_mov_b32 v117, v9
    v_mov_b32 v118, v9
    v_mov_b32 v119, v9
    v_mov_b32 v120, v9
    v_mov_b32 v121, v9
    v_mov_b32 v122, v9
    v_mov_b32 v123, v9
    v_mov_b32 v124, v9
    v_mov_b32 v125, v9
    v_mov_b32 v126, v9
    v_mov_b32 v127, v9
    s_cmp_ge_u32 s13, 1
    s_cbranch_scc1 L_k2_fix_done
    v_mov_b32 v128, v9
    v_mov_b32 v129, v9
    v_mov_b32 v130, v9
    v_mov_b32 v131, v9
    v_mov_b32 v132, v9
    v_mov_b32 v133, v9
    v_mov_b32 v134, v9
    v_mov_b32 v135, v9
    v_mov_b32 v136, v9
    v_mov_b32 v137, v9
    v_mov_b32 v138, v9
    v_mov_b32 v139, v9
    v_mov_b32 v140, v9
    v_mov_b32 v141, v9
    v_mov_b32 v142, v9
    v_mov_b32 v143, v9
L_k2_fix_done:
    v_cndmask_b32 v144, v16, v144, s[32:33]
    v_cndmask_b32 v145, v17, v145, s[34:35]
    v_cndmask_b32 v146, v18, v146, s[36:37]
    v_cndmask_b32 v147, v19, v147, s[38:39]
    v_cndmask_b32 v148, v20, v148, s[40:41]
    v_cndmask_b32 v149, v21, v149, s[42:43]
    v_cndmask_b32 v150, v22, v150, s[44:45]
    v_cndmask_b32 v151, v23, v151, s[46:47]
    v_cndmask_b32 v152, v24, v152, s[48:49]
    v_cndmask_b32 v153, v25, v153, s[50:51]
    v_cndmask_b32 v154, v26, v154, s[52:53]
    v_cndmask_b32 v155, v27, v155, s[54:55]
    v_cndmask_b32 v156, v28, v156, s[56:57]
    v_cndmask_b32 v157, v29, v157, s[58:59]
    v_cndmask_b32 v158, v30, v158, s[60:61]
    v_cndmask_b32 v159, v31, v159, s[62:63]
    v_max3_f32 v10, v32, v33, v34
    v_max3_f32 v11, v64, v65, v66
    v_max3_f32 v12, v96, v97, v98
    v_max3_f32 v13, v128, v129, v130
    v_max3_f32 v10, v35, v36, v10
    v_max3_f32 v11, v67, v68, v11
    v_max3_f32 v12, v99, v100, v12
    v_max3_f32 v13, v131, v132, v13
    v_max3_f32 v10, v37, v38, v10
    v_max3_f32 v11, v69, v70, v11
    v_max3_f32 v12, v101, v102, v12
    v_max3_f32 v13, v133, v134, v13
    v_max3_f32 v10, v39, v40, v10
    v_max3_f32 v11, v71, v72, v11
    v_max3_f32 v12, v103, v104, v12
    v_max3_f32 v13, v135, v136, v13
    v_max3_f32 v10, v41, v42, v10
    v_max3_f32 v11, v73, v74, v11
    v_max3_f32 v12, v105, v106, v12
    v_max3_f32 v13, v137, v138, v13
    v_max3_f32 v10, v43, v44, v10
    v_max3_f32 v11, v75, v76, v11
    v_max3_f32 v12, v107, v108, v12
    v_max3_f32 v13, v139, v140, v13
    v_max3_f32 v10, v45, v46, v10
    v_max3_f32 v11, v77, v78, v11
    v_max3_f32 v12, v109, v110, v12
    v_max3_f32 v13, v141, v142, v13
    v_max3_f32 v10, v47, v48, v10
    v_max3_f32 v11, v79, v80, v11
    v_max3_f32 v12, v111, v112, v12
    v_max3_f32 v13, v143, v144, v13
    v_max3_f32 v10, v49, v50, v10
    v_max3_f32 v11, v81, v82, v11
    v_max3_f32 v12, v113, v114, v12
    v_max3_f32 v13, v145, v146, v13
    v_max3_f32 v10, v51, v52, v10
    v_max3_f32 v11, v83, v84, v11
    v_max3_f32 v12, v115, v116, v12
    v_max3_f32 v13, v147, v148, v13
    v_max3_f32 v10, v53, v54, v10
    v_max3_f32 v11, v85, v86, v11
    v_max3_f32 v12, v117, v118, v12
    v_max3_f32 v13, v149, v150, v13
    v_max3_f32 v10, v55, v56, v10
    v_max3_f32 v11, v87, v88, v11
    v_max3_f32 v12, v119, v120, v12
    v_max3_f32 v13, v151, v152, v13
    v_max3_f32 v10, v57, v58, v10
    v_max3_f32 v11, v89, v90, v11
    v_max3_f32 v12, v121, v122, v12
    v_max3_f32 v13, v153, v154, v13
    v_max3_f32 v10, v59, v60, v10
    v_max3_f32 v11, v91, v92, v11
    v_max3_f32 v12, v123, v124, v12
    v_max3_f32 v13, v155, v156, v13
    v_max3_f32 v10, v61, v62, v10
    v_max3_f32 v11, v93, v94, v11
    v_max3_f32 v12, v125, v126, v12
    v_max3_f32 v13, v157, v158, v13
    v_max_f32 v10, v63, v10
    v_max_f32 v11, v95, v11
    v_max_f32 v12, v127, v12
    v_max_f32 v13, v159, v13
    v_max3_f32 v10, v10, v11, v12
    v_max_f32 v10, v10, v13
    v_mov_b32 v11, v10
    s_nop 1
    v_permlane32_swap_b32 v10, v11
    v_max_f32 v10, v10, v11
    v_mul_f32 v10, v15, v10
    v_mov_b32 v242, v10
    v_mov_b32 v243, v10
    ds_read_b128 v[196:199], v7
    v_add_u32 v7, v7, v14
    ds_read_b128 v[200:203], v7
    v_add_u32 v7, v7, v14
    v_pk_fma_f32 v[144:145], v[144:145], v[240:241], v[242:243] neg_lo:[0,0,1] neg_hi:[0,0,1]
    v_pk_fma_f32 v[146:147], v[146:147], v[240:241], v[242:243] neg_lo:[0,0,1] neg_hi:[0,0,1]
    v_pk_fma_f32 v[148:149], v[148:149], v[240:241], v[242:243] neg_lo:[0,0,1] neg_hi:[0,0,1]
    v_pk_fma_f32 v[150:151], v[150:151], v[240:241], v[242:243] neg_lo:[0,0,1] neg_hi:[0,0,1]
    v_pk_fma_f32 v[152:153], v[152:153], v[240:241], v[242:243] neg_lo:[0,0,1] neg_hi:[0,0,1]
    v_pk_fma_f32 v[154:155], v[154:155], v[240:241], v[242:243] neg_lo:[0,0,1] neg_hi:[0,0,1]
    v_pk_fma_f32 v[156:157], v[156:157], v[240:241], v[242:243] neg_lo:[0,0,1] neg_hi:[0,0,1]
    v_pk_fma_f32 v[158:159], v[158:159], v[240:241], v[242:243] neg_lo:[0,0,1] neg_hi:[0,0,1]
    v_exp_f32 v144, v144
    v_exp_f32 v145, v145
    v_exp_f32 v146, v146
    v_exp_f32 v147, v147
    v_exp_f32 v148, v148
    v_exp_f32 v149, v149
    v_exp_f32 v150, v150
    v_exp_f32 v151, v151
    v_exp_f32 v152, v152
    v_exp_f32 v153, v153
    v_exp_f32 v154, v154
    v_exp_f32 v155, v155
    v_exp_f32 v156, v156
    v_exp_f32 v157, v157
    v_exp_f32 v158, v158
    v_exp_f32 v159, v159
    v_cvt_pk_bf16_f32 v144, v144, v145
    v_cvt_pk_bf16_f32 v145, v146, v147
    v_cvt_pk_bf16_f32 v146, v148, v149
    v_cvt_pk_bf16_f32 v147, v150, v151
    v_cvt_pk_bf16_f32 v148, v152, v153
    v_cvt_pk_bf16_f32 v149, v154, v155
    v_cvt_pk_bf16_f32 v150, v156, v157
    v_cvt_pk_bf16_f32 v151, v158, v159
    v_and_b32 v24, v144, v232
    v_and_b32 v25, v145, v233
    v_and_b32 v26, v146, v234
    v_and_b32 v27, v147, v235
    v_and_b32 v28, v148, v236
    v_and_b32 v29, v149, v237
    v_and_b32 v30, v150, v238
    v_and_b32 v31, v151, v239
    v_xor_b32 v16, v144, v24
    v_xor_b32 v17, v145, v25
    v_xor_b32 v18, v146, v26
    v_xor_b32 v19, v147, v27
    v_xor_b32 v20, v148, v28
    v_xor_b32 v21, v149, v29
    v_xor_b32 v22, v150, v30
    v_xor_b32 v23, v151, v31
    v_mov_b32 v144, v24
    v_mov_b32 v145, v25
    v_mov_b32 v146, v26
    v_mov_b32 v147, v27
    v_mov_b32 v148, v28
    v_mov_b32 v149, v29
    v_mov_b32 v150, v30
    v_mov_b32 v151, v31
    ds_read_b128 v[204:207], v7
    v_add_u32 v7, v7, v14
    ds_read_b128 v[208:211], v7
    v_add_u32 v7, v7, v14
    v_pk_fma_f32 v[32:33], v[32:33], v[240:241], v[242:243] neg_lo:[0,0,1] neg_hi:[0,0,1]
    v_pk_fma_f32 v[34:35], v[34:35], v[240:241], v[242:243] neg_lo:[0,0,1] neg_hi:[0,0,1]
    v_pk_fma_f32 v[36:37], v[36:37], v[240:241], v[242:243] neg_lo:[0,0,1] neg_hi:[0,0,1]
    v_pk_fma_f32 v[38:39], v[38:39], v[240:241], v[242:243] neg_lo:[0,0,1] neg_hi:[0,0,1]
    v_pk_fma_f32 v[40:41], v[40:41], v[240:241], v[242:243] neg_lo:[0,0,1] neg_hi:[0,0,1]
    v_pk_fma_f32 v[42:43], v[42:43], v[240:241], v[242:243] neg_lo:[0,0,1] neg_hi:[0,0,1]
    v_pk_fma_f32 v[44:45], v[44:45], v[240:241], v[242:243] neg_lo:[0,0,1] neg_hi:[0,0,1]
    v_pk_fma_f32 v[46:47], v[46:47], v[240:241], v[242:243] neg_lo:[0,0,1] neg_hi:[0,0,1]
    v_exp_f32 v32, v32
    v_exp_f32 v33, v33
    v_exp_f32 v34, v34
    v_exp_f32 v35, v35
    v_exp_f32 v36, v36
    v_exp_f32 v37, v37
    v_exp_f32 v38, v38
    v_exp_f32 v39, v39
    v_exp_f32 v40, v40
    v_exp_f32 v41, v41
    v_exp_f32 v42, v42
    v_exp_f32 v43, v43
    v_exp_f32 v44, v44
    v_exp_f32 v45, v45
    v_exp_f32 v46, v46
    v_exp_f32 v47, v47
    v_cvt_pk_bf16_f32 v32, v32, v33
    v_cvt_pk_bf16_f32 v33, v34, v35
    v_cvt_pk_bf16_f32 v34, v36, v37
    v_cvt_pk_bf16_f32 v35, v38, v39
    v_cvt_pk_bf16_f32 v36, v40, v41
    v_cvt_pk_bf16_f32 v37, v42, v43
    v_cvt_pk_bf16_f32 v38, v44, v45
    v_cvt_pk_bf16_f32 v39, v46, v47
    s_waitcnt lgkmcnt(2)
    v_mfma_f32_32x32x16_bf16 v[216:231], v[196:199], v[16:19], 0
    v_mfma_f32_32x32x16_bf16 v[216:231], v[200:203], v[20:23], v[216:231]
    ds_read_b128 v[196:199], v7
    v_add_u32 v7, v7, v14
    ds_read_b128 v[200:203], v7
    v_add_u32 v7, v7, v14
    v_pk_fma_f32 v[48:49], v[48:49], v[240:241], v[242:243] neg_lo:[0,0,1] neg_hi:[0,0,1]
    v_pk_fma_f32 v[50:51], v[50:51], v[240:241], v[242:243] neg_lo:[0,0,1] neg_hi:[0,0,1]
    v_pk_fma_f32 v[52:53], v[52:53], v[240:241], v[242:243] neg_lo:[0,0,1] neg_hi:[0,0,1]
    v_pk_fma_f32 v[54:55], v[54:55], v[240:241], v[242:243] neg_lo:[0,0,1] neg_hi:[0,0,1]
    v_pk_fma_f32 v[56:57], v[56:57], v[240:241], v[242:243] neg_lo:[0,0,1] neg_hi:[0,0,1]
    v_pk_fma_f32 v[58:59], v[58:59], v[240:241], v[242:243] neg_lo:[0,0,1] neg_hi:[0,0,1]
    v_pk_fma_f32 v[60:61], v[60:61], v[240:241], v[242:243] neg_lo:[0,0,1] neg_hi:[0,0,1]
    v_pk_fma_f32 v[62:63], v[62:63], v[240:241], v[242:243] neg_lo:[0,0,1] neg_hi:[0,0,1]
    v_exp_f32 v48, v48
    v_exp_f32 v49, v49
    v_exp_f32 v50, v50
    v_exp_f32 v51, v51
    v_exp_f32 v52, v52
    v_exp_f32 v53, v53
    v_exp_f32 v54, v54
    v_exp_f32 v55, v55
    v_exp_f32 v56, v56
    v_exp_f32 v57, v57
    v_exp_f32 v58, v58
    v_exp_f32 v59, v59
    v_exp_f32 v60, v60
    v_exp_f32 v61, v61
    v_exp_f32 v62, v62
    v_exp_f32 v63, v63
    v_cvt_pk_bf16_f32 v48, v48, v49
    v_cvt_pk_bf16_f32 v49, v50, v51
    v_cvt_pk_bf16_f32 v50, v52, v53
    v_cvt_pk_bf16_f32 v51, v54, v55
    v_cvt_pk_bf16_f32 v52, v56, v57
    v_cvt_pk_bf16_f32 v53, v58, v59
    v_cvt_pk_bf16_f32 v54, v60, v61
    v_cvt_pk_bf16_f32 v55, v62, v63
    s_waitcnt lgkmcnt(2)
    v_mfma_f32_32x32x16_bf16 v[216:231], v[204:207], v[32:35], v[216:231]
    v_mfma_f32_32x32x16_bf16 v[216:231], v[208:211], v[36:39], v[216:231]
    ds_read_b128 v[204:207], v7
    v_add_u32 v7, v7, v14
    ds_read_b128 v[208:211], v7
    v_add_u32 v7, v7, v14
    v_pk_fma_f32 v[64:65], v[64:65], v[240:241], v[242:243] neg_lo:[0,0,1] neg_hi:[0,0,1]
    v_pk_fma_f32 v[66:67], v[66:67], v[240:241], v[242:243] neg_lo:[0,0,1] neg_hi:[0,0,1]
    v_pk_fma_f32 v[68:69], v[68:69], v[240:241], v[242:243] neg_lo:[0,0,1] neg_hi:[0,0,1]
    v_pk_fma_f32 v[70:71], v[70:71], v[240:241], v[242:243] neg_lo:[0,0,1] neg_hi:[0,0,1]
    v_pk_fma_f32 v[72:73], v[72:73], v[240:241], v[242:243] neg_lo:[0,0,1] neg_hi:[0,0,1]
    v_pk_fma_f32 v[74:75], v[74:75], v[240:241], v[242:243] neg_lo:[0,0,1] neg_hi:[0,0,1]
    v_pk_fma_f32 v[76:77], v[76:77], v[240:241], v[242:243] neg_lo:[0,0,1] neg_hi:[0,0,1]
    v_pk_fma_f32 v[78:79], v[78:79], v[240:241], v[242:243] neg_lo:[0,0,1] neg_hi:[0,0,1]
    v_exp_f32 v64, v64
    v_exp_f32 v65, v65
    v_exp_f32 v66, v66
    v_exp_f32 v67, v67
    v_exp_f32 v68, v68
    v_exp_f32 v69, v69
    v_exp_f32 v70, v70
    v_exp_f32 v71, v71
    v_exp_f32 v72, v72
    v_exp_f32 v73, v73
    v_exp_f32 v74, v74
    v_exp_f32 v75, v75
    v_exp_f32 v76, v76
    v_exp_f32 v77, v77
    v_exp_f32 v78, v78
    v_exp_f32 v79, v79
    v_cvt_pk_bf16_f32 v64, v64, v65
    v_cvt_pk_bf16_f32 v65, v66, v67
    v_cvt_pk_bf16_f32 v66, v68, v69
    v_cvt_pk_bf16_f32 v67, v70, v71
    v_cvt_pk_bf16_f32 v68, v72, v73
    v_cvt_pk_bf16_f32 v69, v74, v75
    v_cvt_pk_bf16_f32 v70, v76, v77
    v_cvt_pk_bf16_f32 v71, v78, v79
    s_waitcnt lgkmcnt(2)
    v_mfma_f32_32x32x16_bf16 v[216:231], v[196:199], v[48:51], v[216:231]
    v_mfma_f32_32x32x16_bf16 v[216:231], v[200:203], v[52:55], v[216:231]
    ds_read_b128 v[196:199], v7
    v_add_u32 v7, v7, v14
    ds_read_b128 v[200:203], v7
    v_add_u32 v7, v7, v14
    v_pk_fma_f32 v[80:81], v[80:81], v[240:241], v[242:243] neg_lo:[0,0,1] neg_hi:[0,0,1]
    v_pk_fma_f32 v[82:83], v[82:83], v[240:241], v[242:243] neg_lo:[0,0,1] neg_hi:[0,0,1]
    v_pk_fma_f32 v[84:85], v[84:85], v[240:241], v[242:243] neg_lo:[0,0,1] neg_hi:[0,0,1]
    v_pk_fma_f32 v[86:87], v[86:87], v[240:241], v[242:243] neg_lo:[0,0,1] neg_hi:[0,0,1]
    v_pk_fma_f32 v[88:89], v[88:89], v[240:241], v[242:243] neg_lo:[0,0,1] neg_hi:[0,0,1]
    v_pk_fma_f32 v[90:91], v[90:91], v[240:241], v[242:243] neg_lo:[0,0,1] neg_hi:[0,0,1]
    v_pk_fma_f32 v[92:93], v[92:93], v[240:241], v[242:243] neg_lo:[0,0,1] neg_hi:[0,0,1]
    v_pk_fma_f32 v[94:95], v[94:95], v[240:241], v[242:243] neg_lo:[0,0,1] neg_hi:[0,0,1]
    v_exp_f32 v80, v80
    v_exp_f32 v81, v81
    v_exp_f32 v82, v82
    v_exp_f32 v83, v83
    v_exp_f32 v84, v84
    v_exp_f32 v85, v85
    v_exp_f32 v86, v86
    v_exp_f32 v87, v87
    v_exp_f32 v88, v88
    v_exp_f32 v89, v89
    v_exp_f32 v90, v90
    v_exp_f32 v91, v91
    v_exp_f32 v92, v92
    v_exp_f32 v93, v93
    v_exp_f32 v94, v94
    v_exp_f32 v95, v95
    v_cvt_pk_bf16_f32 v80, v80, v81
    v_cvt_pk_bf16_f32 v81, v82, v83
    v_cvt_pk_bf16_f32 v82, v84, v85
    v_cvt_pk_bf16_f32 v83, v86, v87
    v_cvt_pk_bf16_f32 v84, v88, v89
    v_cvt_pk_bf16_f32 v85, v90, v91
    v_cvt_pk_bf16_f32 v86, v92, v93
    v_cvt_pk_bf16_f32 v87, v94, v95
    s_waitcnt lgkmcnt(2)
    v_mfma_f32_32x32x16_bf16 v[216:231], v[204:207], v[64:67], v[216:231]
    v_mfma_f32_32x32x16_bf16 v[216:231], v[208:211], v[68:71], v[216:231]
    ds_read_b128 v[204:207], v7
    v_add_u32 v7, v7, v14
    ds_read_b128 v[208:211], v7
    v_add_u32 v7, v7, v14
    v_pk_fma_f32 v[96:97], v[96:97], v[240:241], v[242:243] neg_lo:[0,0,1] neg_hi:[0,0,1]
    v_pk_fma_f32 v[98:99], v[98:99], v[240:241], v[242:243] neg_lo:[0,0,1] neg_hi:[0,0,1]
    v_pk_fma_f32 v[100:101], v[100:101], v[240:241], v[242:243] neg_lo:[0,0,1] neg_hi:[0,0,1]
    v_pk_fma_f32 v[102:103], v[102:103], v[240:241], v[242:243] neg_lo:[0,0,1] neg_hi:[0,0,1]
    v_pk_fma_f32 v[104:105], v[104:105], v[240:241], v[242:243] neg_lo:[0,0,1] neg_hi:[0,0,1]
    v_pk_fma_f32 v[106:107], v[106:107], v[240:241], v[242:243] neg_lo:[0,0,1] neg_hi:[0,0,1]
    v_pk_fma_f32 v[108:109], v[108:109], v[240:241], v[242:243] neg_lo:[0,0,1] neg_hi:[0,0,1]
    v_pk_fma_f32 v[110:111], v[110:111], v[240:241], v[242:243] neg_lo:[0,0,1] neg_hi:[0,0,1]
    v_exp_f32 v96, v96
    v_exp_f32 v97, v97
    v_exp_f32 v98, v98
    v_exp_f32 v99, v99
    v_exp_f32 v100, v100
    v_exp_f32 v101, v101
    v_exp_f32 v102, v102
    v_exp_f32 v103, v103
    v_exp_f32 v104, v104
    v_exp_f32 v105, v105
    v_exp_f32 v106, v106
    v_exp_f32 v107, v107
    v_exp_f32 v108, v108
    v_exp_f32 v109, v109
    v_exp_f32 v110, v110
    v_exp_f32 v111, v111
    v_cvt_pk_bf16_f32 v96, v96, v97
    v_cvt_pk_bf16_f32 v97, v98, v99
    v_cvt_pk_bf16_f32 v98, v100, v101
    v_cvt_pk_bf16_f32 v99, v102, v103
    v_cvt_pk_bf16_f32 v100, v104, v105
    v_cvt_pk_bf16_f32 v101, v106, v107
    v_cvt_pk_bf16_f32 v102, v108, v109
    v_cvt_pk_bf16_f32 v103, v110, v111
    s_waitcnt lgkmcnt(2)
    v_mfma_f32_32x32x16_bf16 v[216:231], v[196:199], v[80:83], v[216:231]
    v_mfma_f32_32x32x16_bf16 v[216:231], v[200:203], v[84:87], v[216:231]
    ds_read_b128 v[196:199], v7
    v_add_u32 v7, v7, v14
    ds_read_b128 v[200:203], v7
    v_add_u32 v7, v7, v14
    v_pk_fma_f32 v[112:113], v[112:113], v[240:241], v[242:243] neg_lo:[0,0,1] neg_hi:[0,0,1]
    v_pk_fma_f32 v[114:115], v[114:115], v[240:241], v[242:243] neg_lo:[0,0,1] neg_hi:[0,0,1]
    v_pk_fma_f32 v[116:117], v[116:117], v[240:241], v[242:243] neg_lo:[0,0,1] neg_hi:[0,0,1]
    v_pk_fma_f32 v[118:119], v[118:119], v[240:241], v[242:243] neg_lo:[0,0,1] neg_hi:[0,0,1]
    v_pk_fma_f32 v[120:121], v[120:121], v[240:241], v[242:243] neg_lo:[0,0,1] neg_hi:[0,0,1]
    v_pk_fma_f32 v[122:123], v[122:123], v[240:241], v[242:243] neg_lo:[0,0,1] neg_hi:[0,0,1]
    v_pk_fma_f32 v[124:125], v[124:125], v[240:241], v[242:243] neg_lo:[0,0,1] neg_hi:[0,0,1]
    v_pk_fma_f32 v[126:127], v[126:127], v[240:241], v[242:243] neg_lo:[0,0,1] neg_hi:[0,0,1]
    v_exp_f32 v112, v112
    v_exp_f32 v113, v113
    v_exp_f32 v114, v114
    v_exp_f32 v115, v115
    v_exp_f32 v116, v116
    v_exp_f32 v117, v117
    v_exp_f32 v118, v118
    v_exp_f32 v119, v119
    v_exp_f32 v120, v120
    v_exp_f32 v121, v121
    v_exp_f32 v122, v122
    v_exp_f32 v123, v123
    v_exp_f32 v124, v124
    v_exp_f32 v125, v125
    v_exp_f32 v126, v126
    v_exp_f32 v127, v127
    v_cvt_pk_bf16_f32 v112, v112, v113
    v_cvt_pk_bf16_f32 v113, v114, v115
    v_cvt_pk_bf16_f32 v114, v116, v117
    v_cvt_pk_bf16_f32 v115, v118, v119
    v_cvt_pk_bf16_f32 v116, v120, v121
    v_cvt_pk_bf16_f32 v117, v122, v123
    v_cvt_pk_bf16_f32 v118, v124, v125
    v_cvt_pk_bf16_f32 v119, v126, v127
    s_waitcnt lgkmcnt(2)
    v_mfma_f32_32x32x16_bf16 v[216:231], v[204:207], v[96:99], v[216:231]
    v_mfma_f32_32x32x16_bf16 v[216:231], v[208:211], v[100:103], v[216:231]
    ds_read_b128 v[204:207], v7
    v_add_u32 v7, v7, v14
    ds_read_b128 v[208:211], v7
    v_add_u32 v7, v7, v14
    v_pk_fma_f32 v[128:129], v[128:129], v[240:241], v[242:243] neg_lo:[0,0,1] neg_hi:[0,0,1]
    v_pk_fma_f32 v[130:131], v[130:131], v[240:241], v[242:243] neg_lo:[0,0,1] neg_hi:[0,0,1]
    v_pk_fma_f32 v[132:133], v[132:133], v[240:241], v[242:243] neg_lo:[0,0,1] neg_hi:[0,0,1]
    v_pk_fma_f32 v[134:135], v[134:135], v[240:241], v[242:243] neg_lo:[0,0,1] neg_hi:[0,0,1]
    v_pk_fma_f32 v[136:137], v[136:137], v[240:241], v[242:243] neg_lo:[0,0,1] neg_hi:[0,0,1]
    v_pk_fma_f32 v[138:139], v[138:139], v[240:241], v[242:243] neg_lo:[0,0,1] neg_hi:[0,0,1]
    v_pk_fma_f32 v[140:141], v[140:141], v[240:241], v[242:243] neg_lo:[0,0,1] neg_hi:[0,0,1]
    v_pk_fma_f32 v[142:143], v[142:143], v[240:241], v[242:243] neg_lo:[0,0,1] neg_hi:[0,0,1]
    v_exp_f32 v128, v128
    v_exp_f32 v129, v129
    v_exp_f32 v130, v130
    v_exp_f32 v131, v131
    v_exp_f32 v132, v132
    v_exp_f32 v133, v133
    v_exp_f32 v134, v134
    v_exp_f32 v135, v135
    v_exp_f32 v136, v136
    v_exp_f32 v137, v137
    v_exp_f32 v138, v138
    v_exp_f32 v139, v139
    v_exp_f32 v140, v140
    v_exp_f32 v141, v141
    v_exp_f32 v142, v142
    v_exp_f32 v143, v143
    v_cvt_pk_bf16_f32 v128, v128, v129
    v_cvt_pk_bf16_f32 v129, v130, v131
    v_cvt_pk_bf16_f32 v130, v132, v133
    v_cvt_pk_bf16_f32 v131, v134, v135
    v_cvt_pk_bf16_f32 v132, v136, v137
    v_cvt_pk_bf16_f32 v133, v138, v139
    v_cvt_pk_bf16_f32 v134, v140, v141
    v_cvt_pk_bf16_f32 v135, v142, v143
    s_waitcnt lgkmcnt(2)
    v_mfma_f32_32x32x16_bf16 v[216:231], v[196:199], v[112:115], v[216:231]
    v_mfma_f32_32x32x16_bf16 v[216:231], v[200:203], v[116:119], v[216:231]
    ds_read_b128 v[196:199], v7
    v_add_u32 v7, v7, v14
    ds_read_b128 v[200:203], v7
    v_add_u32 v7, v7, v14
    s_waitcnt lgkmcnt(2)
    v_mfma_f32_32x32x16_bf16 v[216:231], v[204:207], v[128:131], v[216:231]
    v_mfma_f32_32x32x16_bf16 v[216:231], v[208:211], v[132:135], v[216:231]
    s_waitcnt lgkmcnt(0)
    v_mfma_f32_32x32x16_bf16 v[216:231], v[196:199], v[144:147], v[216:231]
    v_mfma_f32_32x32x16_bf16 v[216:231], v[200:203], v[148:151], v[216:231]
    s_nop 7
    s_nop 7
    v_rcp_f32 v10, v224
    s_nop 0
    v_mul_f32 v216, v10, v216
    v_mul_f32 v217, v10, v217
    v_mul_f32 v218, v10, v218
    v_mul_f32 v219, v10, v219
    v_mul_f32 v220, v10, v220
    v_mul_f32 v221, v10, v221
    v_mul_f32 v222, v10, v222
    v_mul_f32 v223, v10, v223
    v_cvt_pk_bf16_f32 v16, v216, v217
    v_cvt_pk_bf16_f32 v17, v218, v219
    v_cvt_pk_bf16_f32 v18, v220, v221
    v_cvt_pk_bf16_f32 v19, v222, v223
    buffer_store_dwordx4 v[16:19], v5, s[24:27], s17 offen sc1
L_k2_end:
    s_endpgm

.globl oproj_kernel
.p2align 8
.type oproj_kernel,@function
oproj_kernel:
    s_cmp_ge_u32 s2, 256
    s_cbranch_scc1 L_k3_end
    s_load_dwordx4 s[4:7], s[0:1], 16
    s_load_dwordx2 s[8:9], s[0:1], 40
    s_and_b32 s10, s2, 7
    s_lshr_b32 s11, s2, 3
    s_lshr_b32 s13, s10, 1
    s_lshl_b32 s13, s13, 3
    s_and_b32 s12, s11, 7
    s_add_u32 s13, s13, s12
    s_lshr_b32 s12, s11, 3
    s_and_b32 s11, s10, 1
    s_lshl_b32 s11, s11, 2
    s_add_u32 s12, s12, s11
    v_lshrrev_b32 v1, 6, v0
    v_and_b32 v2, 63, v0
    v_readfirstlane_b32 s39, v1
    v_and_b32 v3, 31, v2
    v_lshrrev_b32 v4, 5, v2
    s_and_b32 s14, s39, 3
    v_lshlrev_b32 v5, 4, v2
    s_cmp_ge_u32 s39, 4
    s_cbranch_scc1 L_k3_loader
    s_lshr_b32 s28, s14, 1
    s_and_b32 s29, s14, 1
    s_lshl_b32 s30, s28, 10
    v_add_u32 v12, s30, v5
    v_bfe_u32 v9, v2, 2, 2
    v_lshl_add_u32 v10, v4, 2, v9
    v_lshlrev_b32 v10, 7, v10
    v_lshrrev_b32 v9, 1, v9
    v_xor_b32 v9, s29, v9
    v_lshl_add_u32 v10, v9, 6, v10
    v_bfe_u32 v9, v2, 4, 1
    v_lshl_add_u32 v10, v9, 5, v10
    v_and_b32 v9, 3, v2
    v_lshl_add_u32 v13, v9, 3, v10
    v_add_u32 v13, 0x10000, v13
    v_add_u32 v14, 0x8000, v13
    v_add_u32 v15, 0x8000, v12
    s_waitcnt lgkmcnt(0)
    s_mov_b32 s16, s6
    s_and_b32 s17, s7, 0xffff
    s_mov_b32 s18, 0x200000
    s_mov_b32 s19, 0x00020000
    s_mov_b32 s24, s8
    s_and_b32 s25, s9, 0xffff
    s_mov_b32 s26, 0x1000000
    s_mov_b32 s27, 0x00020000
    s_barrier
    ds_read_b128 v[32:35], v12 offset:0
    ds_read_b64_tr_b16 v[36:37], v13 offset:0
    ds_read_b64_tr_b16 v[38:39], v13 offset:1024
    ds_read_b128 v[40:43], v12 offset:2048
    ds_read_b64_tr_b16 v[44:45], v13 offset:2048
    ds_read_b64_tr_b16 v[46:47], v13 offset:3072
    s_waitcnt lgkmcnt(3)
    v_mfma_f32_32x32x16_bf16 v[64:79], v[36:39], v[32:35], 0
    ds_read_b128 v[48:51], v12 offset:4096
    ds_read_b64_tr_b16 v[52:53], v13 offset:4096
    ds_read_b64_tr_b16 v[54:55], v13 offset:5120
    s_waitcnt lgkmcnt(3)
    v_mfma_f32_32x32x16_bf16 v[64:79], v[44:47], v[40:43], v[64:79]
    ds_read_b128 v[32:35], v12 offset:6144
    ds_read_b64_tr_b16 v[36:37], v13 offset:6144
    ds_read_b64_tr_b16 v[38:39], v13 offset:7168
    s_barrier
    s_waitcnt lgkmcnt(3)
    v_mfma_f32_32x32x16_bf16 v[64:79], v[52:55], v[48:51], v[64:79]
    ds_read_b128 v[40:43], v12 offset:8192
    ds_read_b64_tr_b16 v[44:45], v13 offset:8192
    ds_read_b64_tr_b16 v[46:47], v13 offset:9216
    s_waitcnt lgkmcnt(3)
    v_mfma_f32_32x32x16_bf16 v[64:79], v[36:39], v[32:35], v[64:79]
    ds_read_b128 v[48:51], v12 offset:10240
    ds_read_b64_tr_b16 v[52:53], v13 offset:10240
    ds_read_b64_tr_b16 v[54:55], v13 offset:11264
    s_waitcnt lgkmcnt(3)
    v_mfma_f32_32x32x16_bf16 v[64:79], v[44:47], v[40:43], v[64:79]
    ds_read_b128 v[32:35], v12 offset:12288
    ds_read_b64_tr_b16 v[36:37], v13 offset:12288
    ds_read_b64_tr_b16 v[38:39], v13 offset:13312
    s_waitcnt lgkmcnt(3)
    v_mfma_f32_32x32x16_bf16 v[64:79], v[52:55], v[48:51], v[64:79]
    ds_read_b128 v[40:43], v12 offset:14336
    ds_read_b64_tr_b16 v[44:45], v13 offset:14336
    ds_read_b64_tr_b16 v[46:47], v13 offset:15360
    s_barrier
    s_waitcnt lgkmcnt(3)
    v_mfma_f32_32x32x16_bf16 v[64:79], v[36:39], v[32:35], v[64:79]
    ds_read_b128 v[48:51], v12 offset:16384
    ds_read_b64_tr_b16 v[52:53], v13 offset:16384
    ds_read_b64_tr_b16 v[54:55], v13 offset:17408
    s_waitcnt lgkmcnt(3)
    v_mfma_f32_32x32x16_bf16 v[64:79], v[44:47], v[40:43], v[64:79]
    ds_read_b128 v[32:35], v12 offset:18432
    ds_read_b64_tr_b16 v[36:37], v13 offset:18432
    ds_read_b64_tr_b16 v[38:39], v13 offset:19456
    s_waitcnt lgkmcnt(3)
    v_mfma_f32_32x32x16_bf16 v[64:79], v[52:55], v[48:51], v[64:79]
    ds_read_b128 v[40:43], v12 offset:20480
    ds_read_b64_tr_b16 v[44:45], v13 offset:20480
    ds_read_b64_tr_b16 v[46:47], v13 offset:21504
    s_waitcnt lgkmcnt(3)
    v_mfma_f32_32x32x16_bf16 v[64:79], v[36:39], v[32:35], v[64:79]
    ds_read_b128 v[48:51], v12 offset:22528
    ds_read_b64_tr_b16 v[52:53], v13 offset:22528
    ds_read_b64_tr_b16 v[54:55], v13 offset:23552
    s_barrier
    s_waitcnt lgkmcnt(3)
    v_mfma_f32_32x32x16_bf16 v[64:79], v[44:47], v[40:43], v[64:79]
    ds_read_b128 v[32:35], v12 offset:24576
    ds_read_b64_tr_b16 v[36:37], v13 offset:24576
    ds_read_b64_tr_b16 v[38:39], v13 offset:25600
    s_waitcnt lgkmcnt(3)
    v_mfma_f32_32x32x16_bf16 v[64:79], v[52:55], v[48:51], v[64:79]
    ds_read_b128 v[40:43], v12 offset:26624
    ds_read_b64_tr_b16 v[44:45], v13 offset:26624
    ds_read_b64_tr_b16 v[46:47], v13 offset:27648
    s_waitcnt lgkmcnt(3)
    v_mfma_f32_32x32x16_bf16 v[64:79], v[36:39], v[32:35], v[64:79]
    ds_read_b128 v[48:51], v12 offset:28672
    ds_read_b64_tr_b16 v[52:53], v13 offset:28672
    ds_read_b64_tr_b16 v[54:55], v13 offset:29696
    s_waitcnt lgkmcnt(3)
    v_mfma_f32_32x32x16_bf16 v[64:79], v[44:47], v[40:43], v[64:79]
    ds_read_b128 v[32:35], v12 offset:30720
    ds_read_b64_tr_b16 v[36:37], v13 offset:30720
    ds_read_b64_tr_b16 v[38:39], v13 offset:31744
    s_barrier
    s_waitcnt lgkmcnt(3)
    v_mfma_f32_32x32x16_bf16 v[64:79], v[52:55], v[48:51], v[64:79]
    ds_read_b128 v[40:43], v15 offset:0
    ds_read_b64_tr_b16 v[44:45], v14 offset:0
    ds_read_b64_tr_b16 v[46:47], v14 offset:1024
    s_waitcnt lgkmcnt(3)
    v_mfma_f32_32x32x16_bf16 v[64:79], v[36:39], v[32:35], v[64:79]
    ds_read_b128 v[48:51], v15 offset:2048
    ds_read_b64_tr_b16 v[52:53], v14 offset:2048
    ds_read_b64_tr_b16 v[54:55], v14 offset:3072
    s_waitcnt lgkmcnt(3)
    v_mfma_f32_32x32x16_bf16 v[64:79], v[44:47], v[40:43], v[64:79]
    ds_read_b128 v[32:35], v15 offset:4096
    ds_read_b64_tr_b16 v[36:37], v14 offset:4096
    ds_read_b64_tr_b16 v[38:39], v14 offset:5120
    s_waitcnt lgkmcnt(3)
    v_mfma_f32_32x32x16_bf16 v[64:79], v[52:55], v[48:51], v[64:79]
    ds_read_b128 v[40:43], v15 offset:6144
    ds_read_b64_tr_b16 v[44:45], v14 offset:6144
    ds_read_b64_tr_b16 v[46:47], v14 offset:7168
    s_barrier
    s_waitcnt lgkmcnt(3)
    v_mfma_f32_32x32x16_bf16 v[64:79], v[36:39], v[32:35], v[64:79]
    ds_read_b128 v[48:51], v15 offset:8192
    ds_read_b64_tr_b16 v[52:53], v14 offset:8192
    ds_read_b64_tr_b16 v[54:55], v14 offset:9216
    s_waitcnt lgkmcnt(3)
    v_mfma_f32_32x32x16_bf16 v[64:79], v[44:47], v[40:43], v[64:79]
    ds_read_b128 v[32:35], v15 offset:10240
    ds_read_b64_tr_b16 v[36:37], v14 offset:10240
    ds_read_b64_tr_b16 v[38:39], v14 offset:11264
    s_waitcnt lgkmcnt(3)
    v_mfma_f32_32x32x16_bf16 v[64:79], v[52:55], v[48:51], v[64:79]
    ds_read_b128 v[40:43], v15 offset:12288
    ds_read_b64_tr_b16 v[44:45], v14 offset:12288
    ds_read_b64_tr_b16 v[46:47], v14 offset:13312
    s_waitcnt lgkmcnt(3)
    v_mfma_f32_32x32x16_bf16 v[64:79], v[36:39], v[32:35], v[64:79]
    ds_read_b128 v[48:51], v15 offset:14336
    ds_read_b64_tr_b16 v[52:53], v14 offset:14336
    ds_read_b64_tr_b16 v[54:55], v14 offset:15360
    s_barrier
    s_waitcnt lgkmcnt(3)
    v_mfma_f32_32x32x16_bf16 v[64:79], v[44:47], v[40:43], v[64:79]
    ds_read_b128 v[32:35], v15 offset:16384
    ds_read_b64_tr_b16 v[36:37], v14 offset:16384
    ds_read_b64_tr_b16 v[38:39], v14 offset:17408
    s_waitcnt lgkmcnt(3)
    v_mfma_f32_32x32x16_bf16 v[64:79], v[52:55], v[48:51], v[64:79]
    ds_read_b128 v[40:43], v15 offset:18432
    ds_read_b64_tr_b16 v[44:45], v14 offset:18432
    ds_read_b64_tr_b16 v[46:47], v14 offset:19456
    s_waitcnt lgkmcnt(3)
    v_mfma_f32_32x32x16_bf16 v[64:79], v[36:39], v[32:35], v[64:79]
    ds_read_b128 v[48:51], v15 offset:20480
    ds_read_b64_tr_b16 v[52:53], v14 offset:20480
    ds_read_b64_tr_b16 v[54:55], v14 offset:21504
    s_waitcnt lgkmcnt(3)
    v_mfma_f32_32x32x16_bf16 v[64:79], v[44:47], v[40:43], v[64:79]
    ds_read_b128 v[32:35], v15 offset:22528
    ds_read_b64_tr_b16 v[36:37], v14 offset:22528
    ds_read_b64_tr_b16 v[38:39], v14 offset:23552
    s_barrier
    s_waitcnt lgkmcnt(3)
    v_mfma_f32_32x32x16_bf16 v[64:79], v[52:55], v[48:51], v[64:79]
    ds_read_b128 v[40:43], v15 offset:24576
    ds_read_b64_tr_b16 v[44:45], v14 offset:24576
    ds_read_b64_tr_b16 v[46:47], v14 offset:25600
    s_waitcnt lgkmcnt(3)
    v_mfma_f32_32x32x16_bf16 v[64:79], v[36:39], v[32:35], v[64:79]
    ds_read_b128 v[48:51], v15 offset:26624
    ds_read_b64_tr_b16 v[52:53], v14 offset:26624
    ds_read_b64_tr_b16 v[54:55], v14 offset:27648
    s_waitcnt lgkmcnt(3)
    v_mfma_f32_32x32x16_bf16 v[64:79], v[44:47], v[40:43], v[64:79]
    ds_read_b128 v[32:35], v15 offset:28672
    ds_read_b64_tr_b16 v[36:37], v14 offset:28672
    ds_read_b64_tr_b16 v[38:39], v14 offset:29696
    s_waitcnt lgkmcnt(3)
    v_mfma_f32_32x32x16_bf16 v[64:79], v[52:55], v[48:51], v[64:79]
    ds_read_b128 v[40:43], v15 offset:30720
    ds_read_b64_tr_b16 v[44:45], v14 offset:30720
    ds_read_b64_tr_b16 v[46:47], v14 offset:31744
    s_waitcnt lgkmcnt(3)
    v_mfma_f32_32x32x16_bf16 v[64:79], v[36:39], v[32:35], v[64:79]
    s_waitcnt lgkmcnt(0)
    v_mfma_f32_32x32x16_bf16 v[64:79], v[44:47], v[40:43], v[64:79]
    s_lshl_b32 s30, s13, 1
    s_add_u32 s30, s30, s28
    s_lshl_b32 s30, s30, 5
    v_add_u32 v5, s30, v3
    v_lshlrev_b32 v5, 10, v5
    v_lshl_add_u32 v5, v4, 4, v5
    s_lshl_b32 s30, s12, 1
    s_add_u32 s30, s30, s29
    s_lshl_b32 s30, s30, 6
    v_add_u32 v5, s30, v5
    s_nop 7
    s_nop 3
    v_cvt_pk_bf16_f32 v16, v64, v65
    v_cvt_pk_bf16_f32 v17, v66, v67
    v_cvt_pk_bf16_f32 v18, v68, v69
    v_cvt_pk_bf16_f32 v19, v70, v71
    v_cvt_pk_bf16_f32 v20, v72, v73
    v_cvt_pk_bf16_f32 v21, v74, v75
    v_cvt_pk_bf16_f32 v22, v76, v77
    v_cvt_pk_bf16_f32 v23, v78, v79
    s_nop 1
    v_permlane32_swap_b32 v16, v18
    v_permlane32_swap_b32 v17, v19
    v_permlane32_swap_b32 v20, v22
    v_permlane32_swap_b32 v21, v23
    buffer_store_dwordx4 v[16:19], v5, s[16:19], 0 offen offset:0
    buffer_store_dwordx4 v[20:23], v5, s[16:19], 0 offen offset:32
    s_endpgm
L_k3_loader:
    v_lshrrev_b32 v9, 3, v2
    v_and_b32 v10, 7, v2
    v_bfe_u32 v11, v2, 4, 1
    v_lshlrev_b32 v11, 2, v11
    v_xor_b32 v10, v10, v11
    v_lshlrev_b32 v9, 10, v9
    v_lshl_add_u32 v9, v10, 4, v9
    s_lshl_b32 s29, s12, 7
    v_add_u32 v6, s29, v9
    v_add_u32 v7, 7168, v6
    s_waitcnt lgkmcnt(0)
    s_mov_b32 s20, s4
    s_and_b32 s21, s5, 0xffff
    s_mov_b32 s22, 0x80000
    s_mov_b32 s23, 0x00020000
    s_mov_b32 s24, s8
    s_and_b32 s25, s9, 0xffff
    s_mov_b32 s26, 0x1000000
    s_mov_b32 s27, 0x00020000
    s_lshl_b32 s36, s14, 11
    s_lshl_b32 s37, s14, 16
    s_lshl_b32 s30, s13, 11
    s_add_u32 s37, s37, s30
    s_add_u32 s37, s37, 0x800000
    s_lshl_b32 s38, s14, 14
    s_add_u32 s30, s36, 0
    s_mov_b32 m0, s30
    s_add_u32 s31, s37, 0
    buffer_load_dwordx4 v5, s[24:27], s31 offen lds
    buffer_load_dwordx4 v5, s[24:27], s31 offen offset:1024 lds
    s_add_u32 s30, s36, 65536
    s_mov_b32 m0, s30
    s_add_u32 s31, s38, 0
    buffer_load_dwordx4 v6, s[20:23], s31 offen lds
    buffer_load_dwordx4 v7, s[20:23], s31 offen offset:1024 lds
    s_add_u32 s30, s36, 8192
    s_mov_b32 m0, s30
    s_add_u32 s31, s37, 262144
    buffer_load_dwordx4 v5, s[24:27], s31 offen lds
    buffer_load_dwordx4 v5, s[24:27], s31 offen offset:1024 lds
    s_add_u32 s30, s36, 73728
    s_mov_b32 m0, s30
    s_add_u32 s31, s38, 65536
    buffer_load_dwordx4 v6, s[20:23], s31 offen lds
    buffer_load_dwordx4 v7, s[20:23], s31 offen offset:1024 lds
    s_add_u32 s30, s36, 16384
    s_mov_b32 m0, s30
    s_add_u32 s31, s37, 524288
    buffer_load_dwordx4 v5, s[24:27], s31 offen lds
    buffer_load_dwordx4 v5, s[24:27], s31 offen offset:1024 lds
    s_add_u32 s30, s36, 81920
    s_mov_b32 m0, s30
    s_add_u32 s31, s38, 131072
    buffer_load_dwordx4 v6, s[20:23], s31 offen lds
    buffer_load_dwordx4 v7, s[20:23], s31 offen offset:1024 lds
    s_add_u32 s30, s36, 24576
    s_mov_b32 m0, s30
    s_add_u32 s31, s37, 786432
    buffer_load_dwordx4 v5, s[24:27], s31 offen lds
    buffer_load_dwordx4 v5, s[24:27], s31 offen offset:1024 lds
    s_add_u32 s30, s36, 90112
    s_mov_b32 m0, s30
    s_add_u32 s31, s38, 196608
    buffer_load_dwordx4 v6, s[20:23], s31 offen lds
    buffer_load_dwordx4 v7, s[20:23], s31 offen offset:1024 lds
    s_waitcnt vmcnt(12)
    s_barrier
    s_add_u32 s30, s36, 32768
    s_mov_b32 m0, s30
    s_add_u32 s31, s37, 1048576
    buffer_load_dwordx4 v5, s[24:27], s31 offen lds
    buffer_load_dwordx4 v5, s[24:27], s31 offen offset:1024 lds
    s_add_u32 s30, s36, 98304
    s_mov_b32 m0, s30
    s_add_u32 s31, s38, 262144
    buffer_load_dwordx4 v6, s[20:23], s31 offen lds
    buffer_load_dwordx4 v7, s[20:23], s31 offen offset:1024 lds
    s_waitcnt vmcnt(12)
    s_barrier
    s_add_u32 s30, s36, 40960
    s_mov_b32 m0, s30
    s_add_u32 s31, s37, 1310720
    buffer_load_dwordx4 v5, s[24:27], s31 offen lds
    buffer_load_dwordx4 v5, s[24:27], s31 offen offset:1024 lds
    s_add_u32 s30, s36, 106496
    s_mov_b32 m0, s30
    s_add_u32 s31, s38, 327680
    buffer_load_dwordx4 v6, s[20:23], s31 offen lds
    buffer_load_dwordx4 v7, s[20:23], s31 offen offset:1024 lds
    s_waitcnt vmcnt(12)
    s_barrier
    s_add_u32 s30, s36, 49152
    s_mov_b32 m0, s30
    s_add_u32 s31, s37, 1572864
    buffer_load_dwordx4 v5, s[24:27], s31 offen lds
    buffer_load_dwordx4 v5, s[24:27], s31 offen offset:1024 lds
    s_add_u32 s30, s36, 114688
    s_mov_b32 m0, s30
    s_add_u32 s31, s38, 393216
    buffer_load_dwordx4 v6, s[20:23], s31 offen lds
    buffer_load_dwordx4 v7, s[20:23], s31 offen offset:1024 lds
    s_waitcnt vmcnt(12)
    s_barrier
    s_add_u32 s30, s36, 57344
    s_mov_b32 m0, s30
    s_add_u32 s31, s37, 1835008
    buffer_load_dwordx4 v5, s[24:27], s31 offen lds
    buffer_load_dwordx4 v5, s[24:27], s31 offen offset:1024 lds
    s_add_u32 s30, s36, 122880
    s_mov_b32 m0, s30
    s_add_u32 s31, s38, 458752
    buffer_load_dwordx4 v6, s[20:23], s31 offen lds
    buffer_load_dwordx4 v7, s[20:23], s31 offen offset:1024 lds
    s_waitcnt vmcnt(12)
    s_barrier
    s_waitcnt vmcnt(8)
    s_barrier
    s_waitcnt vmcnt(4)
    s_barrier
    s_waitcnt vmcnt(0)
    s_barrier
L_k3_end:
    s_endpgm

.section .rodata,"a"
.p2align 6
.amdhsa_kernel qkv_kernel
  .amdhsa_next_free_vgpr 160
  .amdhsa_next_free_sgpr 102
  .amdhsa_accum_offset 160
  .amdhsa_group_segment_fixed_size 0
  .amdhsa_kernarg_size 48
  .amdhsa_user_sgpr_count 2
  .amdhsa_user_sgpr_kernarg_segment_ptr 1
  .amdhsa_system_sgpr_workgroup_id_x 1
.end_amdhsa_kernel
.p2align 6
.amdhsa_kernel attn_kernel
  .amdhsa_next_free_vgpr 256
  .amdhsa_next_free_sgpr 102
  .amdhsa_accum_offset 256
  .amdhsa_group_segment_fixed_size 0
  .amdhsa_kernarg_size 48
  .amdhsa_user_sgpr_count 2
  .amdhsa_user_sgpr_kernarg_segment_ptr 1
  .amdhsa_system_sgpr_workgroup_id_x 1
.end_amdhsa_kernel
.p2align 6
.amdhsa_kernel oproj_kernel
  .amdhsa_next_free_vgpr 80
  .amdhsa_next_free_sgpr 102
  .amdhsa_accum_offset 80
  .amdhsa_group_segment_fixed_size 0
  .amdhsa_kernarg_size 48
  .amdhsa_user_sgpr_count 2
  .amdhsa_user_sgpr_kernarg_segment_ptr 1
  .amdhsa_system_sgpr_workgroup_id_x 1
.end_amdhsa_kernel
```
